```python
import torch

def _softmax(x, axis=-1):
    return torch.softmax(x, dim=axis)
def _gelu(x):
    return torch.nn.functional.gelu(x, approximate="tanh")
def _silu(x):
    return torch.nn.functional.silu(x)
def _sigmoid(x):
    return torch.sigmoid(x)
def _layernorm(x, axis=-1, eps=1e-5):
    m = x.mean(dim=axis, keepdim=True)
    v = x.var(dim=axis, keepdim=True, unbiased=False)
    return (x - m) / torch.sqrt(v + eps)
def _scatter_add(tgt, idx, src, axis=0):
    return tgt.clone().index_add_(axis, idx, src)
def _segment_sum(src, seg, n):
    out = torch.zeros((n,) + src.shape[1:], dtype=src.dtype)
    return out.index_add_(0, seg, src)
def _pad(x, pw):
    flat = tuple(v for pair in reversed(pw) for v in pair)
    return torch.nn.functional.pad(x, flat)

kernel_name = 'gated_mix__mha_block__geglu_ffn__prompt'

def setup_inputs():

    _w = (lambda a: (lambda t: t.to(torch.bfloat16) if t.is_floating_point() else t)(torch.as_tensor(a)))
    def _A_setup():
        B, S, D, H = 1, 2048, 512, 32
        return {
            "x": _w((lambda *s: torch.randn(*s, dtype=torch.bfloat16) * 0.05)(B, S, D)),
            "wqkv": _w((lambda *s: torch.randn(*s, dtype=torch.bfloat16) * 0.8)(D, 3 * D)),
            "wo": _w((lambda *s: torch.randn(*s, dtype=torch.bfloat16) * 0.05)(D, D)),
        }
    _A_in = _A_setup()

    def _B_setup():
        B, S, D, F = 1, 2048, 512, 1376
        return {
            "x": _w((lambda *s: torch.randn(*s, dtype=torch.bfloat16) * 0.05)(B, S, D)),
            "w_gate": _w((lambda *s: torch.randn(*s, dtype=torch.bfloat16) * 0.1)(D, F)),
            "w_up": _w((lambda *s: torch.randn(*s, dtype=torch.bfloat16) * 0.1)(D, F)),
            "w_down": _w((lambda *s: torch.randn(*s, dtype=torch.bfloat16) * 0.1)(F, D)),
        }
    _B_in = _B_setup()

    return {
        "A_x": _A_in["x"],
        "A_wqkv": _A_in["wqkv"],
        "A_wo": _A_in["wo"],
        "B_x": _B_in["x"],
        "B_w_gate": _B_in["w_gate"],
        "B_w_up": _B_in["w_up"],
        "B_w_down": _B_in["w_down"],
        "gate_w": _w((lambda *s: torch.randn(*s, dtype=torch.bfloat16) * 0.05)(512) * 16.0),
    }

def reference(A_x, A_wqkv, A_wo, B_x, B_w_gate, B_w_up, B_w_down, gate_w):
    def _A_ref(x, wqkv, wo):
        B, S, D = x.shape
        H = 32
        Dh = D // H
        qkv = (lambda x, *d: x.permute(*d))((x @ wqkv).reshape(B, S, 3, H, Dh), 2, 0, 3, 1, 4)
        q, k, v = qkv[0], qkv[1], qkv[2]
        scores = torch.einsum("bhqd,bhkd->bhqk", q, k) * (Dh ** -0.5)
        p = _softmax(scores, axis=-1)
        o = torch.einsum("bhqk,bhkd->bhqd", p, v)
        return (lambda x, *d: x.permute(*d))(o, 0, 2, 1, 3).reshape(B, S, D) @ wo

    def _B_ref(x, w_gate, w_up, w_down):
        return (_gelu(x @ w_gate) * (x @ w_up)) @ w_down

    x = A_x
    g = _sigmoid((x * gate_w).sum(-1, keepdims=True))
    a = _A_ref(x, A_wqkv, A_wo)
    b = _B_ref(x, B_w_gate, B_w_up, B_w_down)
    return g * a + (1 - g) * b
```

```asm
; @launch grid=(256,1,1) block=(512,1,1) lds=163840
.amdgcn_target "amdgcn-amd-amdhsa--gfx950"
.text
.p2align 12
.globl gated_mix__mha_block__geglu_ffn__prompt_kernel
.p2align 8
.type gated_mix__mha_block__geglu_ffn__prompt_kernel,@function
gated_mix__mha_block__geglu_ffn__prompt_kernel:
    s_cmp_ge_u32 s2, 256
    s_cbranch_scc1 KF_END
    s_load_dwordx2 s[8:9], s[0:1], 0
    s_load_dwordx2 s[60:61], s[0:1], 8
    s_load_dwordx4 s[64:67], s[0:1], 32
    s_load_dwordx2 s[4:5], s[0:1], 80
    s_load_dwordx2 s[36:37], s[0:1], 56
    s_load_dwordx2 s[20:21], s[0:1], 48
    s_load_dwordx2 s[24:25], s[0:1], 16
    s_load_dwordx2 s[28:29], s[0:1], 64
    s_load_dwordx2 s[32:33], s[0:1], 72
    s_getpc_b64 s[62:63]
KF_PC:
    s_lshr_b32 s70, s2, 3
    v_lshrrev_b32 v1, 5, v0
    v_lshl_add_u32 v1, s70, 4, v1
    v_lshlrev_b32 v1, 7, v1
    s_nop 0
    v_min_u32 v252, KF_CEND-KF_PC-4, v1
    v_mov_b32 v253, 0
    v_lshl_add_u64 v[252:253], v[252:253], 0, s[62:63]
    global_load_dword v255, v[252:253], off
    v_lshrrev_b32 v1, 6, v0
    v_and_b32 v2, 63, v0
    s_and_b32 s70, s2, 1
    v_readfirstlane_b32 s40, v1
    s_lshl_b32 s70, s70, 3
    s_bfe_u32 s71, s2, 0x30003
    s_add_u32 s70, s70, s71
    s_bfe_u32 s72, s2, 0x20001
    s_lshr_b32 s73, s2, 6
    v_lshrrev_b32 v3, 3, v2
    v_lshrrev_b32 v4, 4, v2
    v_and_b32 v5, 7, v2
    v_xor_b32 v5, v5, v4
    v_lshlrev_b32 v5, 4, v5
    v_lshl_add_u32 v22, v3, 10, v5
    s_lshl_b32 s74, s70, 17
    s_lshl_b32 s75, s40, 14
    s_add_u32 s74, s74, s75
    v_add_u32 v22, s74, v22
    v_xor_b32 v23, 64, v22
    v_add_u32 v23, 8192, v23
    s_lshl_b32 s41, s40, 11
    s_mul_i32 s42, s40, 3072
    s_mov_b32 s10, 0x200000
    s_mov_b32 s11, 0x00020000
    s_mov_b32 s62, 76778504
    s_mov_b32 s63, 817641524
    s_bitcmp1_b32 s2, 1
    s_cmov_b32 s62, 447324702
    s_cmov_b32 s63, 1254314574
    s_bitcmp1_b32 s2, 2
    s_cmov_b32 s62, s63
    s_lshl_b32 s63, s73, 3
    s_lshr_b32 s62, s62, s63
    s_bfe_u32 s63, s62, 0x10007
    s_and_b32 s59, s62, 1
    s_and_b32 s62, s62, 126
    s_lshr_b32 s68, s40, 2
    s_and_b32 s69, s40, 3
    s_lshl_b32 s74, s69, 4
    v_lshrrev_b32 v3, 2, v2
    v_add_u32 v3, s74, v3
    v_and_b32 v5, 3, v2
    v_lshlrev_b32 v5, 4, v5
    s_lshl_b32 s74, s68, 5
    v_xor_b32 v6, s74, v5
    s_lshl_b32 s75, s62, 5
    v_mul_u32_u24 v11, 2752, v3
    v_add3_u32 v11, v11, v6, s75
    s_lshl_b32 s74, s73, 10
    s_lshl_b32 s75, s72, 8
    s_add_u32 s74, s74, s75
    s_lshl_b32 s75, s68, 7
    s_add_u32 s74, s74, s75
    v_mul_u32_u24 v24, 3072, v3
    v_add3_u32 v24, v24, v5, s74
    v_subrev_u32 v3, 128, v11
    s_cmp_lt_u32 s73, 3
    s_cselect_b64 vcc, -1, 0
    s_movk_i32 s43, 1376
    s_cmovk_i32 s43, 1536
    v_cndmask_b32 v24, v3, v24, vcc
    s_lshl_b32 s14, s43, 10
    s_mov_b32 s15, 0x00020000
    s_mov_b32 s18, 1409024
    s_mov_b32 s19, 0x00020000
    s_lshl1_add_u32 s3, s73, s71
    s_and_b32 s3, s3, 7
    s_lshl_b32 s3, s3, 7
    s_mul_i32 s44, s3, s43
    s_cmp_eq_u32 s68, 0
    s_waitcnt lgkmcnt(0)
    s_cselect_b32 s16, s64, s66
    s_cselect_b32 s17, s65, s67
    s_cmp_lt_u32 s73, 3
    s_cselect_b32 s12, s60, s16
    s_cselect_b32 s13, s61, s17
    s_cmp_lg_u32 s68, 0
    s_cbranch_scc1 KF_Y1
    s_add_u32 m0, s41, 16384
    s_nop 0
    buffer_load_dwordx4 v22, s[8:11], s3 offen lds
    s_add_u32 m0, s41, 17408
    s_nop 0
    buffer_load_dwordx4 v23, s[8:11], s3 offen lds
    s_add_u32 m0, s41, 0
    s_nop 0
    buffer_load_dwordx4 v24, s[12:15], s44 offen offset:0 lds
    s_add_u32 m0, s41, 960
    s_nop 0
    buffer_load_dwordx4 v24, s[12:15], s44 offen offset:64 lds
    s_add_u32 m0, s41, 49152
    s_add_u32 s3, s3, 128
    s_and_b32 s3, s3, 1023
    buffer_load_dwordx4 v22, s[8:11], s3 offen lds
    s_add_u32 m0, s41, 50176
    s_nop 0
    buffer_load_dwordx4 v23, s[8:11], s3 offen lds
KF_Y1:
    s_mov_b32 s6, 16793600
    s_mov_b32 s7, 0x00020000
    s_movk_i32 s38, 1024
    s_mov_b32 s39, 0x00020000
    v_lshlrev_b32 v10, 4, v2
    s_lshl_b32 s60, s70, 2
    s_add_u32 s60, s60, s69
    s_lshl_b32 s61, s60, 2
    s_add_u32 s61, s61, s72
    s_lshl_b32 s61, s61, 2
    s_add_u32 s61, s61, s73
    s_lshl_b32 s61, s61, 1
    s_add_u32 s61, s61, s68
    s_lshl_b32 s58, s61, 2
    s_add_u32 s58, s58, 16777216
    s_lshl_b32 s61, s61, 10
    v_mov_b32 v104, -1
    v_mov_b32 v105, -1
    v_mov_b32 v106, -1
    v_mov_b32 v107, -1
    v_add_u32 v108, s61, v10
    s_add_u32 s45, s41, 16777216
    s_lshl_b32 s57, s40, 2
    s_cmp_eq_u32 s2, 0
    s_cselect_b32 s45, s45, 1073741824
    s_cselect_b32 s57, s57, 1073741824
    v_and_b32 v6, 32, v6
    v_cmp_eq_u32 vcc, 0, v6
    s_cmp_lg_u32 s63, 0
    s_cselect_b64 vcc, vcc, 0
    v_mov_b32 v12, 1073741824
    s_mul_i32 s74, s59, 160
    v_subrev_u32 v3, s74, v11
    v_cndmask_b32 v12, v12, v3, vcc
    s_lshl_b32 s63, s63, 12
    s_mul_i32 s74, s59, 5120
    s_sub_u32 s63, s63, s74
    v_lshrrev_b32 v5, 5, v2
    v_and_b32 v6, 31, v2
    v_bfe_u32 v3, v2, 1, 3
    v_xor_b32 v3, v3, v5
    v_lshlrev_b32 v3, 4, v3
    v_lshl_add_u32 v16, v6, 7, v3
    s_lshl_b32 s74, s69, 12
    v_add_u32 v16, s74, v16
    v_xor_b32 v17, 32, v16
    v_xor_b32 v18, 64, v16
    v_xor_b32 v19, 96, v16
    v_bfe_u32 v6, v2, 2, 2
    v_bfe_u32 v28, v2, 4, 1
    v_lshl_add_u32 v29, v5, 3, v6
    v_and_b32 v30, 1, v2
    v_lshlrev_b32 v30, 4, v30
    v_and_b32 v3, 2, v2
    v_lshl_add_u32 v30, v3, 2, v30
    v_lshl_add_u32 v30, v28, 5, v30
    v_lshl_add_u32 v31, v29, 6, v30
    s_lshl_b32 s74, s68, 10
    s_lshl_b32 s75, s68, 13
    v_mul_u32_u24 v3, 12288, v28
    v_add3_u32 v8, v31, v3, s74
    v_add_u32 v8, 0x10000, v8
    v_xor_b32 v9, 32, v8
    v_add_u32 v20, s75, v31
    v_add_u32 v21, 1024, v20
    v_lshlrev_b32 v3, 13, v28
    v_add3_u32 v3, v31, v3, s74
    v_xor_b32 v4, 32, v3
    s_cmp_lt_u32 s73, 3
    s_cselect_b64 vcc, -1, 0
    v_cndmask_b32 v20, v3, v20, vcc
    v_cndmask_b32 v21, v4, v21, vcc
    s_lshl_b32 s46, s73, 3
    s_lshl_b32 s74, s72, 1
    s_add_u32 s46, s46, s74
    s_add_u32 s46, s46, s68
    s_lshl_b32 s46, s46, 18
    s_lshl_b32 s74, s60, 10
    s_add_u32 s46, s46, s74
    v_bfe_u32 v3, v2, 2, 1
    v_bfe_u32 v4, v2, 3, 1
    v_xor_b32 v3, v3, v4
    v_mul_u32_u24 v3, 192, v3
    v_xor_b32 v3, v3, v10
    s_cmp_eq_u32 s73, 1
    s_cselect_b64 vcc, -1, 0
    v_cndmask_b32 v7, v10, v3, vcc
    v_and_b32 v3, 15, v2
    v_lshlrev_b32 v4, 4, v3
    v_lshl_add_u32 v4, v5, 8, v4
    v_lshl_add_u32 v4, v28, 16, v4
    s_cmp_eq_u32 s73, 2
    s_cselect_b64 vcc, -1, 0
    s_mov_b32 s47, 0x10000
    s_cmov_b32 s47, 512
    v_cndmask_b32 v7, v7, v4, vcc
    s_cmp_eq_u32 s73, 0
    s_mov_b32 s48, 1.0
    s_cmov_b32 s48, 0x3eb8aa3b
    v_lshlrev_b32 v3, 2, v3
    v_and_b32 v15, 28, v3
    v_mov_b32 v6, 0xbdd2d3e8
    s_mul_i32 s49, s60, 86
    s_add_u32 s49, s49, s62
    s_lshl_b32 s74, s68, 1
    s_add_u32 s49, s49, s74
    s_lshl_b32 s49, s49, 10
    s_add_u32 s49, s49, 6291456
    s_cmp_lg_u32 s63, 0
    s_cselect_b32 s50, 1, 0
    s_cmp_lg_u32 s68, 0
    s_cmov_b32 s50, 0
    s_cmp_eq_u32 s73, 3
    s_cmov_b32 s50, 2
    s_mov_b32 s22, 1409024
    s_mov_b32 s23, 0x00020000
    s_mov_b32 s26, 0x80000
    s_mov_b32 s27, 0x00020000
    s_mov_b32 s30, 0x200000
    s_mov_b32 s31, 0x00020000
    s_movk_i32 s34, 256
    s_mov_b32 s35, 0x00020000
    s_lshl_b32 s67, s72, 11
    s_add_u32 s67, s67, 16785408
    s_lshl2_add_u32 s56, s70, s73
    s_lshl_b32 s56, s56, 5
    s_add_u32 s56, s56, s67
    s_cmp_lg_u32 s40, 0
    s_cmov_b32 s56, 1073741824
    s_and_b32 s70, s2, 7
    s_lshl_b32 s70, s70, 2
    s_add_u32 s70, s70, s73
    s_lshl_b32 s66, s70, 16
    s_add_u32 s64, s66, 0x200000
    s_lshl_b32 s72, s71, 3
    s_add_u32 s72, s72, s40
    s_lshl_b32 s74, s72, 10
    s_add_u32 s66, s66, s74
    s_lshl_b32 s69, s40, 12
    s_mov_b32 s61, 40000
    s_cmp_eq_u32 s68, 0
    s_cbranch_scc1 KF_Y2
    s_add_u32 m0, s41, 16384
    s_nop 0
    buffer_load_dwordx4 v22, s[8:11], s3 offen lds
    s_add_u32 m0, s41, 17408
    s_nop 0
    buffer_load_dwordx4 v23, s[8:11], s3 offen lds
    s_add_u32 m0, s41, 0
    s_nop 0
    buffer_load_dwordx4 v24, s[12:15], s44 offen offset:0 lds
    s_add_u32 m0, s41, 960
    s_nop 0
    buffer_load_dwordx4 v24, s[12:15], s44 offen offset:64 lds
    s_add_u32 m0, s41, 49152
    s_add_u32 s3, s3, 128
    s_and_b32 s3, s3, 1023
    buffer_load_dwordx4 v22, s[8:11], s3 offen lds
    s_add_u32 m0, s41, 50176
    s_nop 0
    buffer_load_dwordx4 v23, s[8:11], s3 offen lds
KF_Y2:
    s_barrier
    s_add_u32 m0, s41, 32768
    s_mul_i32 s44, s3, s43
    buffer_load_dwordx4 v24, s[12:15], s44 offen offset:0 lds
    s_add_u32 m0, s41, 33728
    s_nop 0
    buffer_load_dwordx4 v24, s[12:15], s44 offen offset:64 lds
    s_add_u32 m0, s41, 81920
    s_add_u32 s3, s3, 128
    s_and_b32 s3, s3, 1023
    buffer_load_dwordx4 v22, s[8:11], s3 offen lds
    s_add_u32 m0, s41, 82944
    s_nop 0
    buffer_load_dwordx4 v23, s[8:11], s3 offen lds
    s_add_u32 m0, s41, 65536
    s_mul_i32 s44, s3, s43
    buffer_load_dwordx4 v24, s[12:15], s44 offen offset:0 lds
    s_add_u32 m0, s41, 66496
    s_nop 0
    buffer_load_dwordx4 v24, s[12:15], s44 offen offset:64 lds
    s_cmp_eq_u32 s73, 2
    s_cbranch_scc1 KF_P1V
    s_waitcnt vmcnt(8)
    s_barrier
    ds_read_b128 v[128:131], v16 offset:16384
    ds_read_b64_tr_b16 v[32:33], v20 offset:0
    ds_read_b64_tr_b16 v[34:35], v20 offset:256
    ds_read_b64_tr_b16 v[36:37], v21 offset:0
    ds_read_b64_tr_b16 v[38:39], v21 offset:256
    ds_read_b128 v[132:135], v17 offset:16384
    ds_read_b64_tr_b16 v[40:41], v20 offset:2048
    ds_read_b64_tr_b16 v[42:43], v20 offset:2304
    ds_read_b64_tr_b16 v[44:45], v21 offset:2048
    ds_read_b64_tr_b16 v[46:47], v21 offset:2304
    s_waitcnt lgkmcnt(7)
    v_mfma_f32_32x32x16_bf16 v[64:79], v[32:35], v[128:131], 0
    s_add_u32 m0, s41, 114688
    s_add_u32 s3, s3, 128
    s_and_b32 s3, s3, 1023
    ds_read_b128 v[136:139], v18 offset:16384
    ds_read_b64_tr_b16 v[32:33], v20 offset:4096
    ds_read_b64_tr_b16 v[34:35], v20 offset:4352
    buffer_load_dwordx4 v22, s[8:11], s3 offen lds
    s_waitcnt lgkmcnt(8)
    v_mfma_f32_32x32x16_bf16 v[80:95], v[36:39], v[128:131], 0
    s_add_u32 m0, s41, 115712
    ds_read_b64_tr_b16 v[36:37], v21 offset:4096
    ds_read_b64_tr_b16 v[38:39], v21 offset:4352
    buffer_load_dwordx4 v23, s[8:11], s3 offen lds
    s_waitcnt lgkmcnt(7)
    v_mfma_f32_32x32x16_bf16 v[64:79], v[40:43], v[132:135], v[64:79]
    s_add_u32 m0, s41, 98304
    s_mul_i32 s44, s3, s43
    ds_read_b128 v[140:143], v19 offset:16384
    ds_read_b64_tr_b16 v[40:41], v20 offset:6144
    ds_read_b64_tr_b16 v[42:43], v20 offset:6400
    buffer_load_dwordx4 v24, s[12:15], s44 offen offset:0 lds
    s_waitcnt lgkmcnt(8)
    v_mfma_f32_32x32x16_bf16 v[80:95], v[44:47], v[132:135], v[80:95]
    s_add_u32 m0, s41, 99264
    ds_read_b64_tr_b16 v[44:45], v21 offset:6144
    ds_read_b64_tr_b16 v[46:47], v21 offset:6400
    buffer_load_dwordx4 v24, s[12:15], s44 offen offset:64 lds
    s_waitcnt lgkmcnt(7)
    v_mfma_f32_32x32x16_bf16 v[64:79], v[32:35], v[136:139], v[64:79]
    s_waitcnt vmcnt(8)
    s_barrier
    s_add_u32 m0, s41, 147456
    s_add_u32 s3, s3, 128
    s_and_b32 s3, s3, 1023
    ds_read_b128 v[144:147], v16 offset:49152
    ds_read_b64_tr_b16 v[32:33], v20 offset:32768
    ds_read_b64_tr_b16 v[34:35], v20 offset:33024
    buffer_load_dwordx4 v22, s[8:11], s3 offen lds
    s_waitcnt lgkmcnt(8)
    v_mfma_f32_32x32x16_bf16 v[80:95], v[36:39], v[136:139], v[80:95]
    ds_read_b64_tr_b16 v[36:37], v21 offset:32768
    ds_read_b64_tr_b16 v[38:39], v21 offset:33024
    s_waitcnt lgkmcnt(7)
    v_mfma_f32_32x32x16_bf16 v[64:79], v[40:43], v[140:143], v[64:79]
    s_add_u32 m0, s41, 148480
    ds_read_b128 v[148:151], v17 offset:49152
    ds_read_b64_tr_b16 v[40:41], v20 offset:34816
    ds_read_b64_tr_b16 v[42:43], v20 offset:35072
    buffer_load_dwordx4 v23, s[8:11], s3 offen lds
    s_waitcnt lgkmcnt(8)
    v_mfma_f32_32x32x16_bf16 v[80:95], v[44:47], v[140:143], v[80:95]
    ds_read_b64_tr_b16 v[44:45], v21 offset:34816
    ds_read_b64_tr_b16 v[46:47], v21 offset:35072
    s_waitcnt lgkmcnt(7)
    v_mfma_f32_32x32x16_bf16 v[64:79], v[32:35], v[144:147], v[64:79]
    s_add_u32 m0, s41, 131072
    s_mul_i32 s44, s3, s43
    ds_read_b128 v[152:155], v18 offset:49152
    ds_read_b64_tr_b16 v[32:33], v20 offset:36864
    ds_read_b64_tr_b16 v[34:35], v20 offset:37120
    buffer_load_dwordx4 v24, s[12:15], s44 offen offset:0 lds
    s_waitcnt lgkmcnt(8)
    v_mfma_f32_32x32x16_bf16 v[80:95], v[36:39], v[144:147], v[80:95]
    ds_read_b64_tr_b16 v[36:37], v21 offset:36864
    ds_read_b64_tr_b16 v[38:39], v21 offset:37120
    buffer_store_dwordx4 v[104:107], v10, s[4:7], s45 offen sc1
    s_waitcnt lgkmcnt(7)
    v_mfma_f32_32x32x16_bf16 v[64:79], v[40:43], v[148:151], v[64:79]
    s_add_u32 m0, s41, 132032
    ds_read_b128 v[156:159], v19 offset:49152
    ds_read_b64_tr_b16 v[40:41], v20 offset:38912
    ds_read_b64_tr_b16 v[42:43], v20 offset:39168
    buffer_load_dwordx4 v24, s[12:15], s44 offen offset:64 lds
    s_waitcnt lgkmcnt(8)
    v_mfma_f32_32x32x16_bf16 v[80:95], v[44:47], v[148:151], v[80:95]
    ds_read_b64_tr_b16 v[44:45], v21 offset:38912
    ds_read_b64_tr_b16 v[46:47], v21 offset:39168
    buffer_store_dwordx4 v[104:107], v10, s[4:7], s45 offen offset:1024 sc1
    s_waitcnt lgkmcnt(7)
    v_mfma_f32_32x32x16_bf16 v[64:79], v[32:35], v[152:155], v[64:79]
    s_waitcnt vmcnt(10)
    s_barrier
    s_add_u32 m0, s41, 16384
    s_add_u32 s3, s3, 128
    s_and_b32 s3, s3, 1023
    v_add_u32 v16, 65536, v16
    ds_read_b128 v[160:163], v16 offset:16384
    v_add_u32 v20, 65536, v20
    ds_read_b64_tr_b16 v[32:33], v20 offset:0
    ds_read_b64_tr_b16 v[34:35], v20 offset:256
    buffer_load_dwordx4 v22, s[8:11], s3 offen lds
    s_waitcnt lgkmcnt(8)
    v_mfma_f32_32x32x16_bf16 v[80:95], v[36:39], v[152:155], v[80:95]
    v_add_u32 v21, 65536, v21
    ds_read_b64_tr_b16 v[36:37], v21 offset:0
    ds_read_b64_tr_b16 v[38:39], v21 offset:256
    s_waitcnt lgkmcnt(7)
    v_mfma_f32_32x32x16_bf16 v[64:79], v[40:43], v[156:159], v[64:79]
    s_add_u32 m0, s41, 17408
    v_add_u32 v17, 65536, v17
    ds_read_b128 v[164:167], v17 offset:16384
    ds_read_b64_tr_b16 v[40:41], v20 offset:2048
    ds_read_b64_tr_b16 v[42:43], v20 offset:2304
    buffer_load_dwordx4 v23, s[8:11], s3 offen lds
    s_waitcnt lgkmcnt(8)
    v_mfma_f32_32x32x16_bf16 v[80:95], v[44:47], v[156:159], v[80:95]
    ds_read_b64_tr_b16 v[44:45], v21 offset:2048
    ds_read_b64_tr_b16 v[46:47], v21 offset:2304
    buffer_load_dwordx4 v[96:99], v108, s[8:11], 0 offen
    s_waitcnt lgkmcnt(7)
    v_mfma_f32_32x32x16_bf16 v[64:79], v[32:35], v[160:163], v[64:79]
    s_add_u32 m0, s41, 0
    s_mul_i32 s44, s3, s43
    v_add_u32 v18, 65536, v18
    ds_read_b128 v[168:171], v18 offset:16384
    ds_read_b64_tr_b16 v[32:33], v20 offset:4096
    ds_read_b64_tr_b16 v[34:35], v20 offset:4352
    buffer_load_dwordx4 v24, s[12:15], s44 offen offset:0 lds
    s_waitcnt lgkmcnt(8)
    v_mfma_f32_32x32x16_bf16 v[80:95], v[36:39], v[160:163], v[80:95]
    ds_read_b64_tr_b16 v[36:37], v21 offset:4096
    ds_read_b64_tr_b16 v[38:39], v21 offset:4352
    buffer_load_dwordx4 v[100:103], v10, s[36:39], 0 offen
    s_waitcnt lgkmcnt(7)
    v_mfma_f32_32x32x16_bf16 v[64:79], v[40:43], v[164:167], v[64:79]
    s_add_u32 m0, s41, 960
    v_add_u32 v19, 65536, v19
    ds_read_b128 v[172:175], v19 offset:16384
    ds_read_b64_tr_b16 v[40:41], v20 offset:6144
    ds_read_b64_tr_b16 v[42:43], v20 offset:6400
    buffer_load_dwordx4 v24, s[12:15], s44 offen offset:64 lds
    s_waitcnt lgkmcnt(8)
    v_mfma_f32_32x32x16_bf16 v[80:95], v[44:47], v[164:167], v[80:95]
    ds_read_b64_tr_b16 v[44:45], v21 offset:6144
    ds_read_b64_tr_b16 v[46:47], v21 offset:6400
    s_mov_b32 s74, 12582912
    buffer_store_dwordx4 v[104:107], v108, s[4:7], s74 offen sc1
    s_waitcnt lgkmcnt(7)
    v_mfma_f32_32x32x16_bf16 v[64:79], v[32:35], v[168:171], v[64:79]
    s_waitcnt vmcnt(13)
    s_barrier
    s_add_u32 m0, s41, 49152
    s_add_u32 s3, s3, 128
    s_and_b32 s3, s3, 1023
    ds_read_b128 v[176:179], v16 offset:49152
    ds_read_b64_tr_b16 v[32:33], v20 offset:32768
    ds_read_b64_tr_b16 v[34:35], v20 offset:33024
    buffer_load_dwordx4 v22, s[8:11], s3 offen lds
    s_waitcnt lgkmcnt(8)
    v_mfma_f32_32x32x16_bf16 v[80:95], v[36:39], v[168:171], v[80:95]
    ds_read_b64_tr_b16 v[36:37], v21 offset:32768
    ds_read_b64_tr_b16 v[38:39], v21 offset:33024
    s_waitcnt lgkmcnt(7)
    v_mfma_f32_32x32x16_bf16 v[64:79], v[40:43], v[172:175], v[64:79]
    s_add_u32 m0, s41, 50176
    ds_read_b128 v[180:183], v17 offset:49152
    ds_read_b64_tr_b16 v[40:41], v20 offset:34816
    ds_read_b64_tr_b16 v[42:43], v20 offset:35072
    buffer_load_dwordx4 v23, s[8:11], s3 offen lds
    s_waitcnt lgkmcnt(8)
    v_mfma_f32_32x32x16_bf16 v[80:95], v[44:47], v[172:175], v[80:95]
    ds_read_b64_tr_b16 v[44:45], v21 offset:34816
    ds_read_b64_tr_b16 v[46:47], v21 offset:35072
    s_waitcnt lgkmcnt(7)
    v_mfma_f32_32x32x16_bf16 v[64:79], v[32:35], v[176:179], v[64:79]
    s_add_u32 m0, s41, 32768
    s_mul_i32 s44, s3, s43
    ds_read_b128 v[184:187], v18 offset:49152
    ds_read_b64_tr_b16 v[32:33], v20 offset:36864
    ds_read_b64_tr_b16 v[34:35], v20 offset:37120
    buffer_load_dwordx4 v24, s[12:15], s44 offen offset:0 lds
    s_waitcnt lgkmcnt(8)
    v_mfma_f32_32x32x16_bf16 v[80:95], v[36:39], v[176:179], v[80:95]
    ds_read_b64_tr_b16 v[36:37], v21 offset:36864
    ds_read_b64_tr_b16 v[38:39], v21 offset:37120
    s_waitcnt lgkmcnt(7)
    v_mfma_f32_32x32x16_bf16 v[64:79], v[40:43], v[180:183], v[64:79]
    s_add_u32 m0, s41, 33728
    ds_read_b128 v[188:191], v19 offset:49152
    ds_read_b64_tr_b16 v[40:41], v20 offset:38912
    ds_read_b64_tr_b16 v[42:43], v20 offset:39168
    buffer_load_dwordx4 v24, s[12:15], s44 offen offset:64 lds
    s_waitcnt lgkmcnt(8)
    v_mfma_f32_32x32x16_bf16 v[80:95], v[44:47], v[180:183], v[80:95]
    ds_read_b64_tr_b16 v[44:45], v21 offset:38912
    ds_read_b64_tr_b16 v[46:47], v21 offset:39168
    s_waitcnt lgkmcnt(7)
    v_mfma_f32_32x32x16_bf16 v[64:79], v[32:35], v[184:187], v[64:79]
    s_waitcnt vmcnt(12)
    s_barrier
    s_add_u32 m0, s41, 81920
    s_add_u32 s3, s3, 128
    s_and_b32 s3, s3, 1023
    v_add_u32 v16, 65536, v16
    ds_read_b128 v[192:195], v16 offset:16384
    v_add_u32 v20, 65536, v20
    ds_read_b64_tr_b16 v[32:33], v20 offset:0
    ds_read_b64_tr_b16 v[34:35], v20 offset:256
    buffer_load_dwordx4 v22, s[8:11], s3 offen lds
    s_waitcnt lgkmcnt(8)
    v_mfma_f32_32x32x16_bf16 v[80:95], v[36:39], v[184:187], v[80:95]
    v_add_u32 v21, 65536, v21
    ds_read_b64_tr_b16 v[36:37], v21 offset:0
    ds_read_b64_tr_b16 v[38:39], v21 offset:256
    s_waitcnt lgkmcnt(7)
    v_mfma_f32_32x32x16_bf16 v[64:79], v[40:43], v[188:191], v[64:79]
    s_add_u32 m0, s41, 82944
    v_add_u32 v17, 65536, v17
    ds_read_b128 v[196:199], v17 offset:16384
    ds_read_b64_tr_b16 v[40:41], v20 offset:2048
    ds_read_b64_tr_b16 v[42:43], v20 offset:2304
    buffer_load_dwordx4 v23, s[8:11], s3 offen lds
    s_waitcnt lgkmcnt(8)
    v_mfma_f32_32x32x16_bf16 v[80:95], v[44:47], v[188:191], v[80:95]
    ds_read_b64_tr_b16 v[44:45], v21 offset:2048
    ds_read_b64_tr_b16 v[46:47], v21 offset:2304
    s_waitcnt lgkmcnt(7)
    v_mfma_f32_32x32x16_bf16 v[64:79], v[32:35], v[192:195], v[64:79]
    s_add_u32 m0, s41, 65536
    s_mul_i32 s44, s3, s43
    v_add_u32 v18, 65536, v18
    ds_read_b128 v[200:203], v18 offset:16384
    ds_read_b64_tr_b16 v[32:33], v20 offset:4096
    ds_read_b64_tr_b16 v[34:35], v20 offset:4352
    buffer_load_dwordx4 v24, s[12:15], s44 offen offset:0 lds
    s_waitcnt lgkmcnt(8)
    v_mfma_f32_32x32x16_bf16 v[80:95], v[36:39], v[192:195], v[80:95]
    ds_read_b64_tr_b16 v[36:37], v21 offset:4096
    ds_read_b64_tr_b16 v[38:39], v21 offset:4352
    s_waitcnt lgkmcnt(7)
    v_mfma_f32_32x32x16_bf16 v[64:79], v[40:43], v[196:199], v[64:79]
    s_add_u32 m0, s41, 66496
    v_add_u32 v19, 65536, v19
    ds_read_b128 v[204:207], v19 offset:16384
    ds_read_b64_tr_b16 v[40:41], v20 offset:6144
    ds_read_b64_tr_b16 v[42:43], v20 offset:6400
    buffer_load_dwordx4 v24, s[12:15], s44 offen offset:64 lds
    s_waitcnt lgkmcnt(8)
    v_mfma_f32_32x32x16_bf16 v[80:95], v[44:47], v[196:199], v[80:95]
    ds_read_b64_tr_b16 v[44:45], v21 offset:6144
    ds_read_b64_tr_b16 v[46:47], v21 offset:6400
    s_waitcnt lgkmcnt(7)
    v_mfma_f32_32x32x16_bf16 v[64:79], v[32:35], v[200:203], v[64:79]
    s_waitcnt vmcnt(9)
    s_barrier
    s_mov_b64 exec, 1
    buffer_store_dword v104, off, s[32:35], s57 sc1
    s_mov_b64 exec, -1
    s_add_u32 m0, s42, 98304
    s_add_u32 s3, s3, 128
    s_and_b32 s3, s3, 1023
    s_mul_i32 s45, s3, 1376
    v_subrev_u32 v16, 131072, v16
    ds_read_b128 v[208:211], v16 offset:16384
    v_subrev_u32 v20, 131072, v20
    ds_read_b64_tr_b16 v[32:33], v20 offset:0
    ds_read_b64_tr_b16 v[34:35], v20 offset:256
    buffer_load_dwordx4 v11, s[16:19], s45 offen offset:0 lds
    s_waitcnt lgkmcnt(8)
    v_mfma_f32_32x32x16_bf16 v[80:95], v[36:39], v[200:203], v[80:95]
    v_subrev_u32 v21, 131072, v21
    ds_read_b64_tr_b16 v[36:37], v21 offset:0
    ds_read_b64_tr_b16 v[38:39], v21 offset:256
    s_waitcnt lgkmcnt(7)
    v_mfma_f32_32x32x16_bf16 v[64:79], v[40:43], v[204:207], v[64:79]
    s_add_u32 m0, s42, 99264
    v_subrev_u32 v17, 131072, v17
    ds_read_b128 v[212:215], v17 offset:16384
    ds_read_b64_tr_b16 v[40:41], v20 offset:2048
    ds_read_b64_tr_b16 v[42:43], v20 offset:2304
    buffer_load_dwordx4 v11, s[16:19], s45 offen offset:64 lds
    s_waitcnt lgkmcnt(8)
    v_mfma_f32_32x32x16_bf16 v[80:95], v[44:47], v[204:207], v[80:95]
    ds_read_b64_tr_b16 v[44:45], v21 offset:2048
    ds_read_b64_tr_b16 v[46:47], v21 offset:2304
    s_waitcnt lgkmcnt(7)
    v_mfma_f32_32x32x16_bf16 v[64:79], v[32:35], v[208:211], v[64:79]
    s_add_u32 m0, s42, 100224
    v_subrev_u32 v18, 131072, v18
    ds_read_b128 v[216:219], v18 offset:16384
    ds_read_b64_tr_b16 v[32:33], v20 offset:4096
    ds_read_b64_tr_b16 v[34:35], v20 offset:4352
    buffer_load_dwordx4 v12, s[16:19], s45 offen offset:128 lds
    s_waitcnt lgkmcnt(8)
    v_mfma_f32_32x32x16_bf16 v[80:95], v[36:39], v[208:211], v[80:95]
    ds_read_b64_tr_b16 v[36:37], v21 offset:4096
    ds_read_b64_tr_b16 v[38:39], v21 offset:4352
    s_waitcnt lgkmcnt(7)
    v_mfma_f32_32x32x16_bf16 v[64:79], v[40:43], v[212:215], v[64:79]
    v_subrev_u32 v19, 131072, v19
    ds_read_b128 v[220:223], v19 offset:16384
    ds_read_b64_tr_b16 v[40:41], v20 offset:6144
    ds_read_b64_tr_b16 v[42:43], v20 offset:6400
    s_waitcnt lgkmcnt(8)
    v_mfma_f32_32x32x16_bf16 v[80:95], v[44:47], v[212:215], v[80:95]
    ds_read_b64_tr_b16 v[44:45], v21 offset:6144
    ds_read_b64_tr_b16 v[46:47], v21 offset:6400
    s_waitcnt lgkmcnt(7)
    v_mfma_f32_32x32x16_bf16 v[64:79], v[32:35], v[216:219], v[64:79]
    s_waitcnt vmcnt(8)
    s_barrier
    ds_read_b128 v[224:227], v16 offset:49152
    ds_read_b64_tr_b16 v[32:33], v20 offset:32768
    ds_read_b64_tr_b16 v[34:35], v20 offset:33024
    s_waitcnt lgkmcnt(8)
    v_mfma_f32_32x32x16_bf16 v[80:95], v[36:39], v[216:219], v[80:95]
    ds_read_b64_tr_b16 v[36:37], v21 offset:32768
    ds_read_b64_tr_b16 v[38:39], v21 offset:33024
    s_waitcnt lgkmcnt(7)
    v_mfma_f32_32x32x16_bf16 v[64:79], v[40:43], v[220:223], v[64:79]
    ds_read_b128 v[228:231], v17 offset:49152
    ds_read_b64_tr_b16 v[40:41], v20 offset:34816
    ds_read_b64_tr_b16 v[42:43], v20 offset:35072
    v_dot2_f32_bf16 v1, v96, v100, 0
    v_dot2_f32_bf16 v1, v97, v101, v1
    v_dot2_f32_bf16 v1, v98, v102, v1
    v_dot2_f32_bf16 v1, v99, v103, v1
    s_waitcnt lgkmcnt(8)
    v_mfma_f32_32x32x16_bf16 v[80:95], v[44:47], v[220:223], v[80:95]
    ds_read_b64_tr_b16 v[44:45], v21 offset:34816
    ds_read_b64_tr_b16 v[46:47], v21 offset:35072
    v_add_f32_dpp v1, v1, v1 row_shr:1 bound_ctrl:1
    s_waitcnt lgkmcnt(7)
    v_mfma_f32_32x32x16_bf16 v[64:79], v[32:35], v[224:227], v[64:79]
    ds_read_b128 v[232:235], v18 offset:49152
    ds_read_b64_tr_b16 v[32:33], v20 offset:36864
    ds_read_b64_tr_b16 v[34:35], v20 offset:37120
    v_add_f32_dpp v1, v1, v1 row_shr:2 bound_ctrl:1
    s_waitcnt lgkmcnt(8)
    v_mfma_f32_32x32x16_bf16 v[80:95], v[36:39], v[224:227], v[80:95]
    ds_read_b64_tr_b16 v[36:37], v21 offset:36864
    ds_read_b64_tr_b16 v[38:39], v21 offset:37120
    v_add_f32_dpp v1, v1, v1 row_shr:4 bound_ctrl:1
    s_waitcnt lgkmcnt(7)
    v_mfma_f32_32x32x16_bf16 v[64:79], v[40:43], v[228:231], v[64:79]
    ds_read_b128 v[236:239], v19 offset:49152
    ds_read_b64_tr_b16 v[40:41], v20 offset:38912
    ds_read_b64_tr_b16 v[42:43], v20 offset:39168
    v_add_f32_dpp v1, v1, v1 row_shr:8 bound_ctrl:1
    s_waitcnt lgkmcnt(8)
    v_mfma_f32_32x32x16_bf16 v[80:95], v[44:47], v[228:231], v[80:95]
    ds_read_b64_tr_b16 v[44:45], v21 offset:38912
    ds_read_b64_tr_b16 v[46:47], v21 offset:39168
    v_add_f32_dpp v1, v1, v1 row_bcast:15 row_mask:0xa
    s_waitcnt lgkmcnt(7)
    v_mfma_f32_32x32x16_bf16 v[64:79], v[32:35], v[232:235], v[64:79]
    s_waitcnt vmcnt(4)
    s_barrier
    s_add_u32 m0, s42, 131072
    s_add_u32 s3, s3, 128
    s_and_b32 s3, s3, 1023
    s_mul_i32 s45, s3, 1376
    v_add_u32 v16, 65536, v16
    ds_read_b128 v[240:243], v16 offset:16384
    v_add_u32 v20, 65536, v20
    ds_read_b64_tr_b16 v[32:33], v20 offset:0
    ds_read_b64_tr_b16 v[34:35], v20 offset:256
    buffer_load_dwordx4 v11, s[16:19], s45 offen offset:0 lds
    v_add_f32_dpp v1, v1, v1 row_bcast:31 row_mask:0xc
    s_waitcnt lgkmcnt(8)
    v_mfma_f32_32x32x16_bf16 v[80:95], v[36:39], v[232:235], v[80:95]
    v_add_u32 v21, 65536, v21
    ds_read_b64_tr_b16 v[36:37], v21 offset:0
    ds_read_b64_tr_b16 v[38:39], v21 offset:256
    v_mul_f32 v1, 0xbfb8aa3b, v1
    v_exp_f32 v1, v1
    s_waitcnt lgkmcnt(7)
    v_mfma_f32_32x32x16_bf16 v[64:79], v[40:43], v[236:239], v[64:79]
    s_add_u32 m0, s42, 132032
    v_add_u32 v17, 65536, v17
    ds_read_b128 v[244:247], v17 offset:16384
    ds_read_b64_tr_b16 v[40:41], v20 offset:2048
    ds_read_b64_tr_b16 v[42:43], v20 offset:2304
    buffer_load_dwordx4 v11, s[16:19], s45 offen offset:64 lds
    v_add_f32 v1, 1.0, v1
    v_rcp_f32 v1, v1
    s_waitcnt lgkmcnt(8)
    v_mfma_f32_32x32x16_bf16 v[80:95], v[44:47], v[236:239], v[80:95]
    ds_read_b64_tr_b16 v[44:45], v21 offset:2048
    ds_read_b64_tr_b16 v[46:47], v21 offset:2304
    v_min_u32 v1, -2, v1
    s_waitcnt lgkmcnt(7)
    v_mfma_f32_32x32x16_bf16 v[64:79], v[32:35], v[240:243], v[64:79]
    s_add_u32 m0, s42, 132992
    v_add_u32 v18, 65536, v18
    ds_read_b128 v[248:251], v18 offset:16384
    ds_read_b64_tr_b16 v[32:33], v20 offset:4096
    ds_read_b64_tr_b16 v[34:35], v20 offset:4352
    buffer_load_dwordx4 v12, s[16:19], s45 offen offset:128 lds
    v_readlane_b32 s60, v1, 63
    s_waitcnt lgkmcnt(8)
    v_mfma_f32_32x32x16_bf16 v[80:95], v[36:39], v[240:243], v[80:95]
    ds_read_b64_tr_b16 v[36:37], v21 offset:4096
    ds_read_b64_tr_b16 v[38:39], v21 offset:4352
    s_waitcnt lgkmcnt(7)
    v_mfma_f32_32x32x16_bf16 v[64:79], v[40:43], v[244:247], v[64:79]
    v_add_u32 v19, 65536, v19
    ds_read_b128 v[252:255], v19 offset:16384
    ds_read_b64_tr_b16 v[40:41], v20 offset:6144
    ds_read_b64_tr_b16 v[42:43], v20 offset:6400
    s_waitcnt lgkmcnt(8)
    v_mfma_f32_32x32x16_bf16 v[80:95], v[44:47], v[244:247], v[80:95]
    ds_read_b64_tr_b16 v[44:45], v21 offset:6144
    ds_read_b64_tr_b16 v[46:47], v21 offset:6400
    s_waitcnt lgkmcnt(7)
    v_mfma_f32_32x32x16_bf16 v[64:79], v[32:35], v[248:251], v[64:79]
    s_waitcnt vmcnt(3)
    s_barrier
    buffer_load_dword v14, v15, s[32:35], s69 offen sc1
    s_add_u32 m0, s42, 0
    s_add_u32 s3, s3, 128
    s_and_b32 s3, s3, 1023
    s_mul_i32 s45, s3, 1376
    ds_read_b64_tr_b16 v[32:33], v8 offset:32768
    ds_read_b64_tr_b16 v[34:35], v8 offset:33024
    buffer_load_dwordx4 v11, s[16:19], s45 offen offset:0 lds
    s_waitcnt lgkmcnt(7)
    v_mfma_f32_32x32x16_bf16 v[80:95], v[36:39], v[248:251], v[80:95]
    s_add_u32 m0, s42, 960
    ds_read_b64_tr_b16 v[36:37], v9 offset:32768
    ds_read_b64_tr_b16 v[38:39], v9 offset:33024
    buffer_load_dwordx4 v11, s[16:19], s45 offen offset:64 lds
    s_waitcnt lgkmcnt(6)
    v_mfma_f32_32x32x16_bf16 v[64:79], v[40:43], v[252:255], v[64:79]
    s_add_u32 m0, s42, 1920
    ds_read_b64_tr_b16 v[40:41], v8 offset:35840
    ds_read_b64_tr_b16 v[42:43], v8 offset:36096
    buffer_load_dwordx4 v12, s[16:19], s45 offen offset:128 lds
    s_waitcnt lgkmcnt(6)
    v_mfma_f32_32x32x16_bf16 v[80:95], v[44:47], v[252:255], v[80:95]
    ds_read_b64_tr_b16 v[44:45], v9 offset:35840
    ds_read_b64_tr_b16 v[46:47], v9 offset:36096
KF_P2:
    s_cmp_eq_u32 s50, 1
    s_cbranch_scc1 KF_P2A
    s_cmp_eq_u32 s50, 2
    s_cbranch_scc1 KF_P2C
    s_waitcnt lgkmcnt(6)
    v_mfma_f32_32x32x16_bf16 v[96:111], v[32:35], v[128:131], 0
    ds_read_b64_tr_b16 v[32:33], v8 offset:38912
    ds_read_b64_tr_b16 v[34:35], v8 offset:39168
    s_waitcnt lgkmcnt(6)
    v_mfma_f32_32x32x16_bf16 v[112:127], v[36:39], v[128:131], 0
    ds_read_b64_tr_b16 v[36:37], v9 offset:38912
    ds_read_b64_tr_b16 v[38:39], v9 offset:39168
    v_mul_f32 v64, s48, v64
    v_mul_f32 v65, s48, v65
    v_mul_f32 v66, s48, v66
    v_mul_f32 v67, s48, v67
    v_mul_f32 v68, s48, v68
    v_mul_f32 v69, s48, v69
    v_mul_f32 v70, s48, v70
    v_mul_f32 v71, s48, v71
    s_waitcnt lgkmcnt(6)
    v_mfma_f32_32x32x16_bf16 v[96:111], v[40:43], v[132:135], v[96:111]
    ds_read_b64_tr_b16 v[40:41], v8 offset:41984
    ds_read_b64_tr_b16 v[42:43], v8 offset:42240
    v_cvt_pk_bf16_f32 v64, v64, v65
    v_cvt_pk_bf16_f32 v65, v66, v67
    v_cvt_pk_bf16_f32 v66, v68, v69
    v_cvt_pk_bf16_f32 v67, v70, v71
    buffer_store_dwordx4 v[64:67], v7, s[4:7], s46 offen sc1
    v_mul_f32 v72, s48, v72
    v_mul_f32 v73, s48, v73
    s_waitcnt lgkmcnt(6)
    v_mfma_f32_32x32x16_bf16 v[112:127], v[44:47], v[132:135], v[112:127]
    ds_read_b64_tr_b16 v[44:45], v9 offset:41984
    ds_read_b64_tr_b16 v[46:47], v9 offset:42240
    v_mul_f32 v74, s48, v74
    v_mul_f32 v75, s48, v75
    v_mul_f32 v76, s48, v76
    v_mul_f32 v77, s48, v77
    v_mul_f32 v78, s48, v78
    v_mul_f32 v79, s48, v79
    v_cvt_pk_bf16_f32 v72, v72, v73
    v_cvt_pk_bf16_f32 v73, v74, v75
    s_waitcnt lgkmcnt(6)
    v_mfma_f32_32x32x16_bf16 v[96:111], v[32:35], v[136:139], v[96:111]
    s_waitcnt vmcnt(5)
    s_barrier
    v_add_u32 v8, 65536, v8
    ds_read_b64_tr_b16 v[32:33], v8 offset:0
    ds_read_b64_tr_b16 v[34:35], v8 offset:256
    v_cvt_pk_bf16_f32 v74, v76, v77
    v_cvt_pk_bf16_f32 v75, v78, v79
    s_add_u32 s74, s46, s47
    buffer_store_dwordx4 v[72:75], v7, s[4:7], s74 offen sc1
    v_mul_f32 v80, s48, v80
    v_mul_f32 v81, s48, v81
    v_mul_f32 v82, s48, v82
    v_mul_f32 v83, s48, v83
    s_waitcnt lgkmcnt(6)
    v_mfma_f32_32x32x16_bf16 v[112:127], v[36:39], v[136:139], v[112:127]
    v_add_u32 v9, 65536, v9
    ds_read_b64_tr_b16 v[36:37], v9 offset:0
    ds_read_b64_tr_b16 v[38:39], v9 offset:256
    v_mul_f32 v84, s48, v84
    v_mul_f32 v85, s48, v85
    v_mul_f32 v86, s48, v86
    v_mul_f32 v87, s48, v87
    v_cvt_pk_bf16_f32 v80, v80, v81
    v_cvt_pk_bf16_f32 v81, v82, v83
    v_cvt_pk_bf16_f32 v82, v84, v85
    v_cvt_pk_bf16_f32 v83, v86, v87
    s_waitcnt lgkmcnt(6)
    v_mfma_f32_32x32x16_bf16 v[96:111], v[40:43], v[140:143], v[96:111]
    ds_read_b64_tr_b16 v[40:41], v8 offset:3072
    ds_read_b64_tr_b16 v[42:43], v8 offset:3328
    s_add_u32 s46, s46, 0x20000
    buffer_store_dwordx4 v[80:83], v7, s[4:7], s46 offen sc1
    v_mul_f32 v88, s48, v88
    v_mul_f32 v89, s48, v89
    v_mul_f32 v90, s48, v90
    v_mul_f32 v91, s48, v91
    v_mul_f32 v92, s48, v92
    v_mul_f32 v93, s48, v93
    s_waitcnt lgkmcnt(6)
    v_mfma_f32_32x32x16_bf16 v[112:127], v[44:47], v[140:143], v[112:127]
    ds_read_b64_tr_b16 v[44:45], v9 offset:3072
    ds_read_b64_tr_b16 v[46:47], v9 offset:3328
    v_mul_f32 v94, s48, v94
    v_mul_f32 v95, s48, v95
    v_cvt_pk_bf16_f32 v88, v88, v89
    v_cvt_pk_bf16_f32 v89, v90, v91
    v_cvt_pk_bf16_f32 v90, v92, v93
    v_cvt_pk_bf16_f32 v91, v94, v95
    s_add_u32 s74, s46, s47
    buffer_store_dwordx4 v[88:91], v7, s[4:7], s74 offen sc1
    s_waitcnt lgkmcnt(6)
    v_mfma_f32_32x32x16_bf16 v[96:111], v[32:35], v[144:147], v[96:111]
    s_add_u32 m0, s42, 32768
    s_add_u32 s3, s3, 128
    s_and_b32 s3, s3, 1023
    s_mul_i32 s45, s3, 1376
    ds_read_b64_tr_b16 v[32:33], v8 offset:6144
    ds_read_b64_tr_b16 v[34:35], v8 offset:6400
    buffer_load_dwordx4 v11, s[16:19], s45 offen offset:0 lds
    s_waitcnt lgkmcnt(6)
    v_mfma_f32_32x32x16_bf16 v[112:127], v[36:39], v[144:147], v[112:127]
    s_add_u32 m0, s42, 33728
    ds_read_b64_tr_b16 v[36:37], v9 offset:6144
    ds_read_b64_tr_b16 v[38:39], v9 offset:6400
    buffer_load_dwordx4 v11, s[16:19], s45 offen offset:64 lds
    s_waitcnt lgkmcnt(6)
    v_mfma_f32_32x32x16_bf16 v[96:111], v[40:43], v[148:151], v[96:111]
    s_add_u32 m0, s42, 34688
    ds_read_b64_tr_b16 v[40:41], v8 offset:9216
    ds_read_b64_tr_b16 v[42:43], v8 offset:9472
    buffer_load_dwordx4 v12, s[16:19], s45 offen offset:128 lds
    s_waitcnt lgkmcnt(6)
    v_mfma_f32_32x32x16_bf16 v[112:127], v[44:47], v[148:151], v[112:127]
    ds_read_b64_tr_b16 v[44:45], v9 offset:9216
    ds_read_b64_tr_b16 v[46:47], v9 offset:9472
    s_waitcnt lgkmcnt(6)
    v_mfma_f32_32x32x16_bf16 v[96:111], v[32:35], v[152:155], v[96:111]
    s_waitcnt vmcnt(7)
    s_barrier
    s_add_u32 m0, s42, 65536
    s_add_u32 s3, s3, 128
    s_and_b32 s3, s3, 1023
    s_mul_i32 s45, s3, 1376
    v_subrev_u32 v8, 131072, v8
    ds_read_b64_tr_b16 v[32:33], v8 offset:0
    ds_read_b64_tr_b16 v[34:35], v8 offset:256
    buffer_load_dwordx4 v11, s[16:19], s45 offen offset:0 lds
    s_waitcnt lgkmcnt(6)
    v_mfma_f32_32x32x16_bf16 v[112:127], v[36:39], v[152:155], v[112:127]
    v_subrev_u32 v9, 131072, v9
    ds_read_b64_tr_b16 v[36:37], v9 offset:0
    ds_read_b64_tr_b16 v[38:39], v9 offset:256
    s_waitcnt lgkmcnt(6)
    v_mfma_f32_32x32x16_bf16 v[96:111], v[40:43], v[156:159], v[96:111]
    s_add_u32 m0, s42, 66496
    ds_read_b64_tr_b16 v[40:41], v8 offset:3072
    ds_read_b64_tr_b16 v[42:43], v8 offset:3328
    buffer_load_dwordx4 v11, s[16:19], s45 offen offset:64 lds
    s_waitcnt lgkmcnt(6)
    v_mfma_f32_32x32x16_bf16 v[112:127], v[44:47], v[156:159], v[112:127]
    ds_read_b64_tr_b16 v[44:45], v9 offset:3072
    ds_read_b64_tr_b16 v[46:47], v9 offset:3328
    s_waitcnt lgkmcnt(6)
    v_mfma_f32_32x32x16_bf16 v[96:111], v[32:35], v[160:163], v[96:111]
    s_add_u32 m0, s42, 67456
    ds_read_b64_tr_b16 v[32:33], v8 offset:6144
    ds_read_b64_tr_b16 v[34:35], v8 offset:6400
    buffer_load_dwordx4 v12, s[16:19], s45 offen offset:128 lds
    s_waitcnt lgkmcnt(6)
    v_mfma_f32_32x32x16_bf16 v[112:127], v[36:39], v[160:163], v[112:127]
    ds_read_b64_tr_b16 v[36:37], v9 offset:6144
    ds_read_b64_tr_b16 v[38:39], v9 offset:6400
    s_waitcnt lgkmcnt(6)
    v_mfma_f32_32x32x16_bf16 v[96:111], v[40:43], v[164:167], v[96:111]
    s_add_u32 m0, s42, 98304
    s_add_u32 s3, s3, 128
    s_and_b32 s3, s3, 1023
    s_mul_i32 s45, s3, 1376
    ds_read_b64_tr_b16 v[40:41], v8 offset:9216
    ds_read_b64_tr_b16 v[42:43], v8 offset:9472
    buffer_load_dwordx4 v11, s[16:19], s45 offen offset:0 lds
    s_waitcnt lgkmcnt(6)
    v_mfma_f32_32x32x16_bf16 v[112:127], v[44:47], v[164:167], v[112:127]
    ds_read_b64_tr_b16 v[44:45], v9 offset:9216
    ds_read_b64_tr_b16 v[46:47], v9 offset:9472
    s_waitcnt lgkmcnt(6)
    v_mfma_f32_32x32x16_bf16 v[96:111], v[32:35], v[168:171], v[96:111]
    s_waitcnt vmcnt(4)
    v_cmp_eq_u32 vcc, s40, v14
    s_cmp_lg_u64 vcc, 0
    s_cbranch_scc1 S0B_SP
S0B_OK:
    s_barrier
    s_mov_b64 exec, 1
    buffer_store_dword v2, off, s[4:7], s56 sc1
    s_mov_b64 exec, -1
    s_add_u32 m0, s42, 99264
    ds_read_b64_tr_b16 v[32:33], v8 offset:32768
    ds_read_b64_tr_b16 v[34:35], v8 offset:33024
    buffer_load_dwordx4 v11, s[16:19], s45 offen offset:64 lds
    s_waitcnt lgkmcnt(6)
    v_mfma_f32_32x32x16_bf16 v[112:127], v[36:39], v[168:171], v[112:127]
    ds_read_b64_tr_b16 v[36:37], v9 offset:32768
    ds_read_b64_tr_b16 v[38:39], v9 offset:33024
    s_waitcnt lgkmcnt(6)
    v_mfma_f32_32x32x16_bf16 v[96:111], v[40:43], v[172:175], v[96:111]
    s_add_u32 m0, s42, 100224
    ds_read_b64_tr_b16 v[40:41], v8 offset:35840
    ds_read_b64_tr_b16 v[42:43], v8 offset:36096
    buffer_load_dwordx4 v12, s[16:19], s45 offen offset:128 lds
    s_lshr_b32 s54, s40, 1
    s_lshl1_add_u32 s54, s71, s54
    s_waitcnt lgkmcnt(6)
    v_mfma_f32_32x32x16_bf16 v[112:127], v[44:47], v[172:175], v[112:127]
    ds_read_b64_tr_b16 v[44:45], v9 offset:35840
    ds_read_b64_tr_b16 v[46:47], v9 offset:36096
    v_and_b32 v0, 3, v2
    v_lshl_add_u32 v0, v0, 2, s54
    s_waitcnt lgkmcnt(6)
    v_mfma_f32_32x32x16_bf16 v[96:111], v[32:35], v[176:179], v[96:111]
    s_add_u32 m0, s42, 131072
    s_add_u32 s3, s3, 128
    s_and_b32 s3, s3, 1023
    s_mul_i32 s45, s3, 1376
    ds_read_b64_tr_b16 v[32:33], v8 offset:38912
    ds_read_b64_tr_b16 v[34:35], v8 offset:39168
    buffer_load_dwordx4 v11, s[16:19], s45 offen offset:0 lds
    v_and_b32 v0, 15, v0
    v_and_b32 v1, 4, v2
    s_waitcnt lgkmcnt(6)
    v_mfma_f32_32x32x16_bf16 v[112:127], v[36:39], v[176:179], v[112:127]
    ds_read_b64_tr_b16 v[36:37], v9 offset:38912
    ds_read_b64_tr_b16 v[38:39], v9 offset:39168
    v_lshlrev_b32 v0, 7, v0
    v_lshl_add_u32 v0, v1, 3, v0
    s_waitcnt lgkmcnt(6)
    v_mfma_f32_32x32x16_bf16 v[96:111], v[40:43], v[180:183], v[96:111]
    s_add_u32 m0, s42, 132032
    ds_read_b64_tr_b16 v[40:41], v8 offset:41984
    ds_read_b64_tr_b16 v[42:43], v8 offset:42240
    buffer_load_dwordx4 v11, s[16:19], s45 offen offset:64 lds
    v_add_u32 v0, 32, v0
    s_waitcnt lgkmcnt(6)
    v_mfma_f32_32x32x16_bf16 v[112:127], v[44:47], v[180:183], v[112:127]
    ds_read_b64_tr_b16 v[44:45], v9 offset:41984
    ds_read_b64_tr_b16 v[46:47], v9 offset:42240
    s_mov_b64 vcc, 0xff
    v_cndmask_b32 v0, 1073741824, v0, vcc
    s_waitcnt lgkmcnt(6)
    v_mfma_f32_32x32x16_bf16 v[96:111], v[32:35], v[184:187], v[96:111]
    s_waitcnt vmcnt(6)
    s_barrier
    s_add_u32 m0, s42, 132992
    v_add_u32 v8, 65536, v8
    ds_read_b64_tr_b16 v[32:33], v8 offset:0
    ds_read_b64_tr_b16 v[34:35], v8 offset:256
    buffer_load_dwordx4 v12, s[16:19], s45 offen offset:128 lds
    s_lshl1_add_u32 s54, s71, s68
    s_lshl_b32 s54, s54, 7
    s_waitcnt lgkmcnt(6)
    v_mfma_f32_32x32x16_bf16 v[112:127], v[36:39], v[184:187], v[112:127]
    v_add_u32 v9, 65536, v9
    ds_read_b64_tr_b16 v[36:37], v9 offset:0
    ds_read_b64_tr_b16 v[38:39], v9 offset:256
    v_writelane_b32 v0, s54, 8
    s_bfe_u32 s62, s70, 0x20001
    s_waitcnt lgkmcnt(6)
    v_mfma_f32_32x32x16_bf16 v[96:111], v[40:43], v[188:191], v[96:111]
    s_add_u32 m0, s42, 0
    s_add_u32 s3, s3, 128
    s_and_b32 s3, s3, 1023
    s_mul_i32 s45, s3, 1376
    ds_read_b64_tr_b16 v[40:41], v8 offset:3072
    ds_read_b64_tr_b16 v[42:43], v8 offset:3328
    buffer_load_dwordx4 v11, s[16:19], s45 offen offset:0 lds
    s_lshl_b32 s62, s62, 5
    s_add_u32 s54, s54, s62
    s_waitcnt lgkmcnt(6)
    v_mfma_f32_32x32x16_bf16 v[112:127], v[44:47], v[188:191], v[112:127]
    s_add_u32 m0, s42, 960
    ds_read_b64_tr_b16 v[44:45], v9 offset:3072
    ds_read_b64_tr_b16 v[46:47], v9 offset:3328
    buffer_load_dwordx4 v11, s[16:19], s45 offen offset:64 lds
    v_writelane_b32 v0, s54, 9
    s_waitcnt lgkmcnt(6)
    v_mfma_f32_32x32x16_bf16 v[96:111], v[32:35], v[192:195], v[96:111]
    s_add_u32 m0, s42, 1920
    ds_read_b64_tr_b16 v[32:33], v8 offset:6144
    ds_read_b64_tr_b16 v[34:35], v8 offset:6400
    buffer_load_dwordx4 v12, s[16:19], s45 offen offset:128 lds
    s_waitcnt lgkmcnt(6)
    v_mfma_f32_32x32x16_bf16 v[112:127], v[36:39], v[192:195], v[112:127]
    ds_read_b64_tr_b16 v[36:37], v9 offset:6144
    ds_read_b64_tr_b16 v[38:39], v9 offset:6400
    s_waitcnt lgkmcnt(6)
    v_mfma_f32_32x32x16_bf16 v[96:111], v[40:43], v[196:199], v[96:111]
    ds_read_b64_tr_b16 v[40:41], v8 offset:9216
    ds_read_b64_tr_b16 v[42:43], v8 offset:9472
    v_lshrrev_b32 v3, 3, v2
    v_and_b32 v4, 7, v2
    v_lshlrev_b32 v4, 4, v4
    v_and_b32 v5, 16, v2
    v_lshlrev_b32 v14, 2, v5
    s_waitcnt lgkmcnt(6)
    v_mfma_f32_32x32x16_bf16 v[112:127], v[44:47], v[196:199], v[112:127]
    ds_read_b64_tr_b16 v[44:45], v9 offset:9216
    ds_read_b64_tr_b16 v[46:47], v9 offset:9472
    v_xor_b32 v4, v4, v14
    v_lshl_add_u32 v14, v3, 10, v4
    s_lshl_b32 s74, s71, 7
    v_add_u32 v14, s74, v14
    s_lshl_b32 s43, s40, 14
    s_waitcnt lgkmcnt(6)
    v_mfma_f32_32x32x16_bf16 v[96:111], v[32:35], v[200:203], v[96:111]
    s_waitcnt vmcnt(6)
    s_barrier
    ds_read_b64_tr_b16 v[32:33], v8 offset:32768
    ds_read_b64_tr_b16 v[34:35], v8 offset:33024
    v_lshrrev_b32 v3, 5, v2
    v_bfe_u32 v4, v2, 2, 2
    v_lshl_add_u32 v4, v3, 3, v4
    v_lshlrev_b32 v4, 7, v4
    v_lshl_add_u32 v4, v5, 1, v4
    s_waitcnt lgkmcnt(6)
    v_mfma_f32_32x32x16_bf16 v[112:127], v[36:39], v[200:203], v[112:127]
    ds_read_b64_tr_b16 v[36:37], v9 offset:32768
    ds_read_b64_tr_b16 v[38:39], v9 offset:33024
    v_and_b32 v5, 1, v2
    v_lshl_add_u32 v4, v5, 4, v4
    v_and_b32 v5, 2, v2
    v_lshl_add_u32 v4, v5, 2, v4
    v_and_b32 v5, 8, v2
    s_waitcnt lgkmcnt(6)
    v_mfma_f32_32x32x16_bf16 v[96:111], v[40:43], v[204:207], v[96:111]
    ds_read_b64_tr_b16 v[40:41], v8 offset:35840
    ds_read_b64_tr_b16 v[42:43], v8 offset:36096
    v_lshl_add_u32 v4, v5, 3, v4
    s_lshr_b32 s74, s40, 1
    s_lshl_b32 s42, s74, 17
    s_lshl_b32 s75, s74, 5
    s_add_u32 s75, s75, s69
    s_waitcnt lgkmcnt(6)
    v_mfma_f32_32x32x16_bf16 v[112:127], v[44:47], v[204:207], v[112:127]
    ds_read_b64_tr_b16 v[44:45], v9 offset:35840
    ds_read_b64_tr_b16 v[46:47], v9 offset:36096
    v_xor_b32 v4, s75, v4
    v_xor_b32 v5, 64, v4
    v_and_b32 v1, 15, v2
    v_lshlrev_b32 v1, 4, v1
    v_lshl_add_u32 v12, v3, 8, v1
    s_waitcnt lgkmcnt(6)
    v_mfma_f32_32x32x16_bf16 v[96:111], v[32:35], v[208:211], v[96:111]
    ds_read_b64_tr_b16 v[32:33], v8 offset:38912
    ds_read_b64_tr_b16 v[34:35], v8 offset:39168
    v_add_u32 v12, 0x8800, v12
    v_add_u32 v13, 0x10000, v12
    s_lshl_b32 s74, s74, 3
    s_and_b32 s75, s40, 1
    s_lshl1_add_u32 s75, s70, s75
    s_waitcnt lgkmcnt(6)
    v_mfma_f32_32x32x16_bf16 v[112:127], v[36:39], v[208:211], v[112:127]
    ds_read_b64_tr_b16 v[36:37], v8 offset:41984
    ds_read_b64_tr_b16 v[38:39], v8 offset:42240
    s_mul_i32 s44, s75, 86
    s_add_u32 s44, s44, s40
    s_lshl_b32 s44, s44, 10
    s_add_u32 s44, s44, 6291456
    s_xor_b32 s45, s75, 1
    s_waitcnt lgkmcnt(6)
    v_mfma_f32_32x32x16_bf16 v[96:111], v[40:43], v[212:215], v[96:111]
    s_waitcnt vmcnt(0)
    s_barrier
    v_add_u32 v8, 65536, v8
    ds_read_b64_tr_b16 v[40:41], v8 offset:0
    ds_read_b64_tr_b16 v[42:43], v8 offset:256
    s_mul_i32 s45, s45, 86
    s_add_u32 s45, s45, s40
    s_lshl_b32 s45, s45, 10
    s_add_u32 s45, s45, 6291456
    s_lshl_b32 s46, s72, 5
    s_waitcnt lgkmcnt(6)
    v_mfma_f32_32x32x16_bf16 v[112:127], v[44:47], v[212:215], v[112:127]
    ds_read_b64_tr_b16 v[44:45], v8 offset:3072
    ds_read_b64_tr_b16 v[46:47], v8 offset:3328
    s_add_u32 s46, s46, s70
    s_lshl_b32 s46, s46, 10
    s_add_u32 s46, s46, 12582912
    s_lshl_b32 s47, s75, 5
    s_waitcnt lgkmcnt(6)
    v_mfma_f32_32x32x16_bf16 v[96:111], v[32:35], v[216:219], v[96:111]
    ds_read_b64_tr_b16 v[32:33], v8 offset:6144
    ds_read_b64_tr_b16 v[34:35], v8 offset:6400
    s_add_u32 s47, s47, s74
    s_lshl_b32 s47, s47, 10
    s_add_u32 s47, s47, 12582912
    s_add_u32 s48, s47, 4096
    s_lshl_b32 s51, s72, 7
    s_waitcnt lgkmcnt(6)
    v_mfma_f32_32x32x16_bf16 v[96:111], v[36:39], v[220:223], v[96:111]
    ds_read_b64_tr_b16 v[36:37], v8 offset:9216
    ds_read_b64_tr_b16 v[38:39], v8 offset:9472
    s_add_u32 s51, s51, 16777216
    s_lshl_b32 s52, s75, 7
    s_add_u32 s52, s52, 16777216
    s_xor_b32 s53, s52, 128
    s_mul_i32 s55, s70, 176128
    s_waitcnt lgkmcnt(6)
    v_mfma_f32_32x32x16_bf16 v[96:111], v[40:43], v[224:227], v[96:111]
    v_subrev_u32 v8, 131072, v8
    ds_read_b64_tr_b16 v[40:41], v8 offset:0
    ds_read_b64_tr_b16 v[42:43], v8 offset:256
    s_add_u32 s55, s55, 6291456
    s_mul_i32 s59, s72, 2816
    s_mov_b32 s56, 0xffff
    s_mov_b32 s57, 0xffff
    v_add_u32 v7, 0x8000, v10
    s_waitcnt lgkmcnt(6)
    v_mfma_f32_32x32x16_bf16 v[96:111], v[44:47], v[228:231], v[96:111]
    ds_read_b64_tr_b16 v[44:45], v8 offset:3072
    ds_read_b64_tr_b16 v[46:47], v8 offset:3328
    v_add_u32 v11, 0x18000, v10
    v_add_u32 v131, s69, v7
    v_mov_b32 v132, v6
    v_mov_b32 v133, 0xc0135761
    v_mov_b32 v15, 0xdddd
    s_waitcnt lgkmcnt(6)
    v_mfma_f32_32x32x16_bf16 v[96:111], v[32:35], v[232:235], v[96:111]
    ds_read_b64_tr_b16 v[32:33], v8 offset:6144
    ds_read_b64_tr_b16 v[34:35], v8 offset:6400
    buffer_load_dword v128, v0, s[4:7], s67 offen sc1
    v_and_b32 v1, 31, v2
    v_lshlrev_b32 v1, 2, v1
    v_mov_b32 v56, 0
    s_mov_b32 exec_lo, 0x110000
    s_mov_b32 exec_hi, 0x110000
    v_mov_b32 v56, 0x3f803f80
    s_mov_b64 exec, -1
    v_mov_b32 v57, v56
    s_waitcnt lgkmcnt(6)
    v_mfma_f32_32x32x16_bf16 v[96:111], v[36:39], v[236:239], v[96:111]
    ds_read_b64_tr_b16 v[36:37], v8 offset:9216
    ds_read_b64_tr_b16 v[38:39], v8 offset:9472
    v_mov_b32 v58, v56
    v_mov_b32 v59, v56
    v_mov_b32 v60, v56
    v_mov_b32 v61, v56
    v_mov_b32 v62, v56
    s_waitcnt lgkmcnt(6)
    v_mfma_f32_32x32x16_bf16 v[96:111], v[40:43], v[240:243], v[96:111]
    ds_read_b64_tr_b16 v[40:41], v9 offset:38912
    ds_read_b64_tr_b16 v[42:43], v9 offset:39168
    v_mov_b32 v63, v56
    v_mov_b32 v64, 0
    v_mov_b32 v65, 0
    v_mov_b32 v66, 0
    v_mov_b32 v67, 0
    s_waitcnt lgkmcnt(6)
    v_mfma_f32_32x32x16_bf16 v[96:111], v[44:47], v[244:247], v[96:111]
    ds_read_b64_tr_b16 v[44:45], v9 offset:41984
    ds_read_b64_tr_b16 v[46:47], v9 offset:42240
    v_mov_b32 v68, 0
    v_mov_b32 v69, 0
    v_mov_b32 v70, 0
    v_mov_b32 v71, 0
    v_mov_b32 v72, 0
    s_waitcnt lgkmcnt(6)
    v_mfma_f32_32x32x16_bf16 v[96:111], v[32:35], v[248:251], v[96:111]
    v_add_u32 v9, 65536, v9
    ds_read_b64_tr_b16 v[32:33], v9 offset:0
    ds_read_b64_tr_b16 v[34:35], v9 offset:256
    s_waitcnt vmcnt(0)
    v_cmp_eq_u32 vcc, -1, v128
    s_and_b32 s62, vcc_lo, 307
    s_cselect_b32 s62, 1073741824, 0
    s_add_u32 s65, s66, s62
    s_add_u32 s54, s64, s62
    buffer_load_dwordx4 v[48:51], v10, s[4:7], s65 offen sc1
    s_add_u32 m0, s69, 32768
    s_lshl_b32 s3, s71, 13
    s_add_u32 s3, s3, s41
    s_and_b32 s3, s3, 0xffff
    s_add_u32 s65, s54, s3
    buffer_load_dwordx4 v10, s[4:7], s65 offen sc1 lds
    v_mov_b32 v73, 0
    v_mov_b32 v74, 0
    v_mov_b32 v75, 0
    v_mov_b32 v76, 0
    v_mov_b32 v77, 0
    s_waitcnt lgkmcnt(6)
    v_mfma_f32_32x32x16_bf16 v[96:111], v[36:39], v[252:255], v[96:111]
    ds_read_b64_tr_b16 v[36:37], v9 offset:3072
    ds_read_b64_tr_b16 v[38:39], v9 offset:3328
    buffer_load_dwordx4 v10, s[4:7], s65 offen offset:1024 sc1 lds
    v_mov_b32 v78, 0
    v_mov_b32 v79, 0
    s_lshl_b32 s75, s73, 17
    s_add_u32 s75, s75, s43
    s_waitcnt lgkmcnt(6)
    v_mfma_f32_32x32x16_bf16 v[112:127], v[40:43], v[216:219], v[112:127]
    ds_read_b64_tr_b16 v[40:41], v9 offset:6144
    ds_read_b64_tr_b16 v[42:43], v9 offset:6400
    s_add_u32 m0, s69, 34816
    s_add_u32 s65, s65, 0x200000
    buffer_load_dwordx4 v10, s[4:7], s65 offen sc1 lds
    buffer_load_dwordx4 v10, s[4:7], s65 offen offset:1024 sc1 lds
    s_waitcnt lgkmcnt(6)
    v_mfma_f32_32x32x16_bf16 v[112:127], v[44:47], v[220:223], v[112:127]
    ds_read_b64_tr_b16 v[44:45], v9 offset:9216
    ds_read_b64_tr_b16 v[46:47], v9 offset:9472
    s_add_u32 m0, s69, 65536
    s_add_u32 s3, s3, 16384
    s_and_b32 s3, s3, 0xffff
    s_add_u32 s65, s54, s3
    buffer_load_dwordx4 v10, s[4:7], s65 offen sc1 lds
    s_waitcnt lgkmcnt(6)
    v_mfma_f32_32x32x16_bf16 v[112:127], v[32:35], v[224:227], v[112:127]
    v_subrev_u32 v9, 131072, v9
    ds_read_b64_tr_b16 v[32:33], v9 offset:0
    ds_read_b64_tr_b16 v[34:35], v9 offset:256
    buffer_load_dwordx4 v10, s[4:7], s65 offen offset:1024 sc1 lds
    s_add_u32 m0, s69, 67584
    s_add_u32 s65, s65, 0x200000
    buffer_load_dwordx4 v10, s[4:7], s65 offen sc1 lds
    s_waitcnt lgkmcnt(6)
    v_mfma_f32_32x32x16_bf16 v[112:127], v[36:39], v[228:231], v[112:127]
    ds_read_b64_tr_b16 v[36:37], v9 offset:3072
    ds_read_b64_tr_b16 v[38:39], v9 offset:3328
    buffer_load_dwordx4 v10, s[4:7], s65 offen offset:1024 sc1 lds
    v_mul_f32 v156, v96, v96
    v_mul_f32 v157, v97, v97
    v_mul_f32 v158, v98, v98
    v_mul_f32 v159, v99, v99
    v_mul_f32 v160, v100, v100
    v_mul_f32 v161, v101, v101
    v_mul_f32 v162, v102, v102
    v_mul_f32 v163, v103, v103
    v_fmaak_f32 v156, v156, v6, 0xc0135761
    v_fmaak_f32 v157, v157, v6, 0xc0135761
    s_waitcnt lgkmcnt(6)
    v_mfma_f32_32x32x16_bf16 v[112:127], v[40:43], v[232:235], v[112:127]
    ds_read_b64_tr_b16 v[40:41], v9 offset:6144
    ds_read_b64_tr_b16 v[42:43], v9 offset:6400
    buffer_load_dword v128, v0, s[4:7], s67 offen sc1
    v_fmaak_f32 v158, v158, v6, 0xc0135761
    v_fmaak_f32 v159, v159, v6, 0xc0135761
    v_fmaak_f32 v160, v160, v6, 0xc0135761
    v_fmaak_f32 v161, v161, v6, 0xc0135761
    v_fmaak_f32 v162, v162, v6, 0xc0135761
    v_fmaak_f32 v163, v163, v6, 0xc0135761
    v_mul_f32 v156, v96, v156
    v_mul_f32 v157, v97, v157
    v_mul_f32 v158, v98, v158
    v_mul_f32 v159, v99, v159
    s_waitcnt lgkmcnt(6)
    v_mfma_f32_32x32x16_bf16 v[112:127], v[44:47], v[236:239], v[112:127]
    ds_read_b64_tr_b16 v[44:45], v9 offset:9216
    ds_read_b64_tr_b16 v[46:47], v9 offset:9472
    v_mul_f32 v160, v100, v160
    v_mul_f32 v161, v101, v161
    v_mul_f32 v162, v102, v162
    v_mul_f32 v163, v103, v163
    v_exp_f32 v156, v156
    v_exp_f32 v157, v157
    v_exp_f32 v158, v158
    v_exp_f32 v159, v159
    v_exp_f32 v160, v160
    v_exp_f32 v161, v161
    s_waitcnt lgkmcnt(6)
    v_mfma_f32_32x32x16_bf16 v[112:127], v[32:35], v[240:243], v[112:127]
    v_exp_f32 v162, v162
    v_exp_f32 v163, v163
    v_mul_f32 v96, v96, v104
    v_mul_f32 v97, v97, v105
    v_mul_f32 v98, v98, v106
    v_mul_f32 v99, v99, v107
    v_mul_f32 v100, v100, v108
    v_mul_f32 v101, v101, v109
    v_mul_f32 v102, v102, v110
    v_mul_f32 v103, v103, v111
    s_waitcnt lgkmcnt(4)
    v_mfma_f32_32x32x16_bf16 v[112:127], v[36:39], v[244:247], v[112:127]
    v_add_f32 v156, 1.0, v156
    v_add_f32 v157, 1.0, v157
    v_add_f32 v158, 1.0, v158
    v_add_f32 v159, 1.0, v159
    v_add_f32 v160, 1.0, v160
    v_add_f32 v161, 1.0, v161
    v_add_f32 v162, 1.0, v162
    v_add_f32 v163, 1.0, v163
    v_rcp_f32 v156, v156
    v_rcp_f32 v157, v157
    s_waitcnt lgkmcnt(2)
    v_mfma_f32_32x32x16_bf16 v[112:127], v[40:43], v[248:251], v[112:127]
    v_rcp_f32 v158, v158
    v_rcp_f32 v159, v159
    v_rcp_f32 v160, v160
    v_rcp_f32 v161, v161
    v_rcp_f32 v162, v162
    v_rcp_f32 v163, v163
    v_mul_f32 v96, v96, v156
    v_mul_f32 v97, v97, v157
    v_mul_f32 v98, v98, v158
    v_mul_f32 v99, v99, v159
    s_waitcnt lgkmcnt(0)
    v_mfma_f32_32x32x16_bf16 v[112:127], v[44:47], v[252:255], v[112:127]
    v_mul_f32 v100, v100, v160
    v_mul_f32 v101, v101, v161
    v_mul_f32 v102, v102, v162
    v_mul_f32 v103, v103, v163
    v_cvt_pk_bf16_f32 v164, v96, v97
    v_cvt_pk_bf16_f32 v165, v98, v99
    v_cvt_pk_bf16_f32 v166, v100, v101
    v_cvt_pk_bf16_f32 v167, v102, v103
    buffer_store_dwordx4 v[164:167], v10, s[4:7], s49 offen offset:0 sc1
    s_cmp_lg_u32 s62, 0
    s_cbranch_scc1 KF_NB
KF_B1B:
    s_waitcnt vmcnt(9)
    ds_read_b128 v[52:55], v131
    s_nop 7
    v_pk_mul_f32 v[144:145], v[112:113], v[112:113]
    v_pk_mul_f32 v[146:147], v[114:115], v[114:115]
    v_pk_mul_f32 v[148:149], v[116:117], v[116:117]
    v_pk_mul_f32 v[150:151], v[118:119], v[118:119]
    v_pk_fma_f32 v[144:145], v[144:145], v[132:133], v[132:133] op_sel:[0,0,1] op_sel_hi:[1,0,1]
    v_pk_fma_f32 v[146:147], v[146:147], v[132:133], v[132:133] op_sel:[0,0,1] op_sel_hi:[1,0,1]
    v_pk_fma_f32 v[148:149], v[148:149], v[132:133], v[132:133] op_sel:[0,0,1] op_sel_hi:[1,0,1]
    v_pk_fma_f32 v[150:151], v[150:151], v[132:133], v[132:133] op_sel:[0,0,1] op_sel_hi:[1,0,1]
    v_pk_mul_f32 v[144:145], v[112:113], v[144:145]
    v_pk_mul_f32 v[146:147], v[114:115], v[146:147]
    v_pk_mul_f32 v[148:149], v[116:117], v[148:149]
    v_pk_mul_f32 v[150:151], v[118:119], v[150:151]
    s_waitcnt lgkmcnt(0)
    v_mfma_f32_32x32x16_bf16 v[32:47], v[52:55], v[48:51], 0
    v_exp_f32 v144, v144
    v_exp_f32 v145, v145
    v_exp_f32 v146, v146
    v_exp_f32 v147, v147
    v_exp_f32 v148, v148
    v_exp_f32 v149, v149
    v_exp_f32 v150, v150
    v_exp_f32 v151, v151
    v_pk_mul_f32 v[112:113], v[112:113], v[120:121]
    v_pk_mul_f32 v[114:115], v[114:115], v[122:123]
    v_pk_mul_f32 v[116:117], v[116:117], v[124:125]
    v_pk_mul_f32 v[118:119], v[118:119], v[126:127]
    v_pk_add_f32 v[144:145], v[144:145], 1.0 op_sel_hi:[1,0]
    v_pk_add_f32 v[146:147], v[146:147], 1.0 op_sel_hi:[1,0]
    v_max3_f32 v3, v32, v33, v34
    v_max3_f32 v3, v3, v35, v36
    v_max3_f32 v3, v3, v37, v38
    v_max3_f32 v3, v3, v39, v40
    v_max3_f32 v3, v3, v41, v42
    v_max3_f32 v3, v3, v43, v44
    v_max3_f32 v3, v3, v45, v46
    v_max_f32 v3, v3, v47
    v_mov_b32 v130, v3
    v_pk_add_f32 v[148:149], v[148:149], 1.0 op_sel_hi:[1,0]
    v_pk_add_f32 v[150:151], v[150:151], 1.0 op_sel_hi:[1,0]
    v_permlane32_swap_b32 v3, v130
    v_rcp_f32 v144, v144
    v_rcp_f32 v145, v145
    v_max_f32 v3, v3, v130
    v_rcp_f32 v146, v146
    v_sub_f32 v80, 0, v3
    v_sub_f32 v81, 0, v3
    v_sub_f32 v82, 0, v3
    v_sub_f32 v83, 0, v3
    v_sub_f32 v84, 0, v3
    v_sub_f32 v85, 0, v3
    v_sub_f32 v86, 0, v3
    v_sub_f32 v87, 0, v3
    v_sub_f32 v88, 0, v3
    v_sub_f32 v89, 0, v3
    v_sub_f32 v90, 0, v3
    v_sub_f32 v91, 0, v3
    v_sub_f32 v92, 0, v3
    v_sub_f32 v93, 0, v3
    v_sub_f32 v94, 0, v3
    v_sub_f32 v95, 0, v3
    v_rcp_f32 v147, v147
    v_rcp_f32 v148, v148
    v_rcp_f32 v149, v149
    v_rcp_f32 v150, v150
    v_rcp_f32 v151, v151
    v_pk_mul_f32 v[112:113], v[112:113], v[144:145]
    v_pk_mul_f32 v[114:115], v[114:115], v[146:147]
    v_pk_mul_f32 v[116:117], v[116:117], v[148:149]
    v_pk_mul_f32 v[118:119], v[118:119], v[150:151]
    v_cvt_pk_bf16_f32 v152, v112, v113
    v_cvt_pk_bf16_f32 v153, v114, v115
    v_cvt_pk_bf16_f32 v154, v116, v117
    v_cvt_pk_bf16_f32 v155, v118, v119
    buffer_store_dwordx4 v[152:155], v10, s[4:7], s49 offen offset:1024 sc1
    s_waitcnt vmcnt(2)
    v_cmp_eq_u32 vcc, -1, v128
    s_or_b32 s74, s62, vcc_lo
    s_cbranch_scc1 KF_LATE
.p2align 3
KF_ATT:
    s_cmp_lg_u32 s68, 0
    s_cselect_b64 vcc, -1, 0
    s_barrier
    ds_read_b128 v[52:55], v7 offset:0
    s_mov_b64 exec, s[56:57]
    ds_read_b128 v[56:59], v12 offset:0
    s_mov_b64 exec, -1
    s_waitcnt lgkmcnt(1)
    v_mfma_f32_32x32x16_bf16 v[16:31], v[52:55], v[48:51], v[80:95]
    ds_read_b128 v[52:55], v7 offset:1024
    s_nop 7
    s_nop 2
    s_cbranch_vccz KF_PP0
    s_setprio 1
KF_PP0:
    v_exp_f32 v16, v16
    v_exp_f32 v17, v17
    v_exp_f32 v18, v18
    s_add_u32 m0, s69, 98304
    s_add_u32 s3, s3, 16384
    s_and_b32 s3, s3, 0xffff
    s_add_u32 s65, s64, s3
    buffer_load_dwordx4 v10, s[4:7], s65 offen sc1 lds
    buffer_load_dwordx4 v10, s[4:7], s65 offen offset:1024 sc1 lds
    v_exp_f32 v19, v19
    s_waitcnt lgkmcnt(0)
    v_exp_f32 v20, v20
    s_mov_b64 exec, s[56:57]
    ds_read_b128 v[60:63], v12 offset:512
    s_mov_b64 exec, -1
    v_exp_f32 v21, v21
    v_exp_f32 v22, v22
    v_exp_f32 v23, v23
    v_mfma_f32_32x32x16_bf16 v[32:47], v[52:55], v[48:51], v[80:95]
    v_exp_f32 v24, v24
    ds_read_b128 v[52:55], v7 offset:4096
    v_exp_f32 v25, v25
    v_exp_f32 v26, v26
    v_exp_f32 v27, v27
    v_smfmac_f32_32x32x32_bf16 v[64:79], v[56:59], v[16:23], v15
    v_exp_f32 v28, v28
    s_mov_b64 exec, s[56:57]
    ds_read_b128 v[56:59], v12 offset:1024
    s_mov_b64 exec, -1
    v_exp_f32 v29, v29
    v_exp_f32 v30, v30
    v_exp_f32 v31, v31
    v_exp_f32 v32, v32
    v_exp_f32 v33, v33
    v_exp_f32 v34, v34
    s_add_u32 m0, s69, 100352
    s_add_u32 s65, s65, 0x200000
    buffer_load_dwordx4 v10, s[4:7], s65 offen sc1 lds
    buffer_load_dwordx4 v10, s[4:7], s65 offen offset:1024 sc1 lds
    v_exp_f32 v35, v35
    s_waitcnt lgkmcnt(0)
    v_smfmac_f32_32x32x32_bf16 v[64:79], v[60:63], v[24:31], v15
    v_exp_f32 v36, v36
    s_mov_b64 exec, s[56:57]
    ds_read_b128 v[60:63], v12 offset:1536
    s_mov_b64 exec, -1
    v_exp_f32 v37, v37
    v_exp_f32 v38, v38
    v_exp_f32 v39, v39
    v_mfma_f32_32x32x16_bf16 v[16:31], v[52:55], v[48:51], v[80:95]
    v_exp_f32 v40, v40
    ds_read_b128 v[52:55], v7 offset:5120
    v_exp_f32 v41, v41
    v_exp_f32 v42, v42
    v_exp_f32 v43, v43
    v_smfmac_f32_32x32x32_bf16 v[64:79], v[56:59], v[32:39], v15
    v_exp_f32 v44, v44
    s_mov_b64 exec, s[56:57]
    ds_read_b128 v[56:59], v12 offset:4096
    s_mov_b64 exec, -1
    v_exp_f32 v45, v45
    v_exp_f32 v46, v46
    v_exp_f32 v47, v47
    s_cbranch_vccz KF_PP2
    s_setprio 0
KF_PP2:
    v_exp_f32 v16, v16
    v_exp_f32 v17, v17
    v_exp_f32 v18, v18
    s_add_u32 m0, s69, 131072
    s_add_u32 s3, s3, 16384
    s_and_b32 s3, s3, 0xffff
    s_add_u32 s65, s64, s3
    buffer_load_dwordx4 v10, s[4:7], s65 offen sc1 lds
    buffer_load_dwordx4 v10, s[4:7], s65 offen offset:1024 sc1 lds
    v_exp_f32 v19, v19
    s_waitcnt lgkmcnt(0)
    v_smfmac_f32_32x32x32_bf16 v[64:79], v[60:63], v[40:47], v15
    v_exp_f32 v20, v20
    s_mov_b64 exec, s[56:57]
    ds_read_b128 v[60:63], v12 offset:4608
    s_mov_b64 exec, -1
    v_exp_f32 v21, v21
    v_exp_f32 v22, v22
    v_exp_f32 v23, v23
    v_mfma_f32_32x32x16_bf16 v[32:47], v[52:55], v[48:51], v[80:95]
    v_exp_f32 v24, v24
    ds_read_b128 v[52:55], v7 offset:8192
    v_exp_f32 v25, v25
    v_exp_f32 v26, v26
    v_exp_f32 v27, v27
    v_smfmac_f32_32x32x32_bf16 v[64:79], v[56:59], v[16:23], v15
    v_exp_f32 v28, v28
    s_mov_b64 exec, s[56:57]
    ds_read_b128 v[56:59], v12 offset:5120
    s_mov_b64 exec, -1
    v_exp_f32 v29, v29
    v_exp_f32 v30, v30
    v_exp_f32 v31, v31
    s_cbranch_vccz KF_PP3
    s_setprio 1
KF_PP3:
    v_exp_f32 v32, v32
    v_exp_f32 v33, v33
    v_exp_f32 v34, v34
    s_add_u32 m0, s69, 133120
    s_add_u32 s65, s65, 0x200000
    buffer_load_dwordx4 v10, s[4:7], s65 offen sc1 lds
    buffer_load_dwordx4 v10, s[4:7], s65 offen offset:1024 sc1 lds
    v_exp_f32 v35, v35
    s_waitcnt lgkmcnt(0)
    v_smfmac_f32_32x32x32_bf16 v[64:79], v[60:63], v[24:31], v15
    v_exp_f32 v36, v36
    s_mov_b64 exec, s[56:57]
    ds_read_b128 v[60:63], v12 offset:5632
    s_mov_b64 exec, -1
    v_exp_f32 v37, v37
    v_exp_f32 v38, v38
    v_exp_f32 v39, v39
    v_mfma_f32_32x32x16_bf16 v[16:31], v[52:55], v[48:51], v[80:95]
    v_exp_f32 v40, v40
    ds_read_b128 v[52:55], v7 offset:9216
    v_exp_f32 v41, v41
    v_exp_f32 v42, v42
    v_exp_f32 v43, v43
    v_smfmac_f32_32x32x32_bf16 v[64:79], v[56:59], v[32:39], v15
    v_exp_f32 v44, v44
    s_mov_b64 exec, s[56:57]
    ds_read_b128 v[56:59], v12 offset:8192
    s_mov_b64 exec, -1
    v_exp_f32 v45, v45
    v_exp_f32 v46, v46
    v_exp_f32 v47, v47
    v_exp_f32 v16, v16
    v_exp_f32 v17, v17
    v_exp_f32 v18, v18
    v_exp_f32 v19, v19
    s_waitcnt lgkmcnt(0)
    v_smfmac_f32_32x32x32_bf16 v[64:79], v[60:63], v[40:47], v15
    v_exp_f32 v20, v20
    s_mov_b64 exec, s[56:57]
    ds_read_b128 v[60:63], v12 offset:8704
    s_mov_b64 exec, -1
    v_exp_f32 v21, v21
    v_exp_f32 v22, v22
    v_exp_f32 v23, v23
    v_mfma_f32_32x32x16_bf16 v[32:47], v[52:55], v[48:51], v[80:95]
    v_exp_f32 v24, v24
    ds_read_b128 v[52:55], v7 offset:12288
    v_exp_f32 v25, v25
    v_exp_f32 v26, v26
    v_exp_f32 v27, v27
    v_smfmac_f32_32x32x32_bf16 v[64:79], v[56:59], v[16:23], v15
    v_exp_f32 v28, v28
    s_mov_b64 exec, s[56:57]
    ds_read_b128 v[56:59], v12 offset:9216
    s_mov_b64 exec, -1
    v_exp_f32 v29, v29
    v_exp_f32 v30, v30
    v_exp_f32 v31, v31
    s_cbranch_vccz KF_PP5
    s_setprio 0
KF_PP5:
    v_exp_f32 v32, v32
    v_exp_f32 v33, v33
    v_exp_f32 v34, v34
    v_exp_f32 v35, v35
    s_waitcnt lgkmcnt(0)
    v_smfmac_f32_32x32x32_bf16 v[64:79], v[60:63], v[24:31], v15
    v_exp_f32 v36, v36
    s_mov_b64 exec, s[56:57]
    ds_read_b128 v[60:63], v12 offset:9728
    s_mov_b64 exec, -1
    v_exp_f32 v37, v37
    v_exp_f32 v38, v38
    v_exp_f32 v39, v39
    v_mfma_f32_32x32x16_bf16 v[16:31], v[52:55], v[48:51], v[80:95]
    v_exp_f32 v40, v40
    ds_read_b128 v[52:55], v7 offset:13312
    v_exp_f32 v41, v41
    v_exp_f32 v42, v42
    v_exp_f32 v43, v43
    v_smfmac_f32_32x32x32_bf16 v[64:79], v[56:59], v[32:39], v15
    v_exp_f32 v44, v44
    s_mov_b64 exec, s[56:57]
    ds_read_b128 v[56:59], v12 offset:12288
    s_mov_b64 exec, -1
    v_exp_f32 v45, v45
    v_exp_f32 v46, v46
    v_exp_f32 v47, v47
    s_cbranch_vccz KF_PP6
    s_setprio 1
KF_PP6:
    v_exp_f32 v16, v16
    v_exp_f32 v17, v17
    v_exp_f32 v18, v18
    v_exp_f32 v19, v19
    s_waitcnt lgkmcnt(0)
    v_smfmac_f32_32x32x32_bf16 v[64:79], v[60:63], v[40:47], v15
    v_exp_f32 v20, v20
    s_mov_b64 exec, s[56:57]
    ds_read_b128 v[60:63], v12 offset:12800
    s_mov_b64 exec, -1
    v_exp_f32 v21, v21
    v_exp_f32 v22, v22
    v_exp_f32 v23, v23
    v_mfma_f32_32x32x16_bf16 v[32:47], v[52:55], v[48:51], v[80:95]
    v_exp_f32 v24, v24
    ds_read_b128 v[52:55], v7 offset:16384
    v_exp_f32 v25, v25
    v_exp_f32 v26, v26
    v_exp_f32 v27, v27
    v_smfmac_f32_32x32x32_bf16 v[64:79], v[56:59], v[16:23], v15
    v_exp_f32 v28, v28
    s_mov_b64 exec, s[56:57]
    ds_read_b128 v[56:59], v12 offset:13312
    s_mov_b64 exec, -1
    v_exp_f32 v29, v29
    v_exp_f32 v30, v30
    v_exp_f32 v31, v31
    v_exp_f32 v32, v32
    v_exp_f32 v33, v33
    v_exp_f32 v34, v34
    v_exp_f32 v35, v35
    s_waitcnt lgkmcnt(0)
    v_smfmac_f32_32x32x32_bf16 v[64:79], v[60:63], v[24:31], v15
    v_exp_f32 v36, v36
    s_mov_b64 exec, s[56:57]
    ds_read_b128 v[60:63], v12 offset:13824
    s_mov_b64 exec, -1
    v_exp_f32 v37, v37
    v_exp_f32 v38, v38
    v_exp_f32 v39, v39
    v_mfma_f32_32x32x16_bf16 v[16:31], v[52:55], v[48:51], v[80:95]
    v_exp_f32 v40, v40
    ds_read_b128 v[52:55], v7 offset:17408
    v_exp_f32 v41, v41
    v_exp_f32 v42, v42
    v_exp_f32 v43, v43
    v_smfmac_f32_32x32x32_bf16 v[64:79], v[56:59], v[32:39], v15
    v_exp_f32 v44, v44
    s_mov_b64 exec, s[56:57]
    ds_read_b128 v[56:59], v12 offset:16384
    s_mov_b64 exec, -1
    v_exp_f32 v45, v45
    v_exp_f32 v46, v46
    v_exp_f32 v47, v47
    s_cbranch_vccz KF_PP8
    s_setprio 0
KF_PP8:
    v_exp_f32 v16, v16
    v_mov_b32 v0, s60
    s_waitcnt vmcnt(8)
    s_mov_b64 exec, 1
    buffer_store_dword v0, off, s[4:7], s58 sc1
    s_mov_b64 exec, -1
    v_exp_f32 v17, v17
    v_exp_f32 v18, v18
    v_exp_f32 v19, v19
    s_waitcnt lgkmcnt(0)
    v_smfmac_f32_32x32x32_bf16 v[64:79], v[60:63], v[40:47], v15
    v_exp_f32 v20, v20
    s_mov_b64 exec, s[56:57]
    ds_read_b128 v[60:63], v12 offset:16896
    s_mov_b64 exec, -1
    v_exp_f32 v21, v21
    s_add_u32 m0, s69, 0
    s_nop 0
    buffer_load_dwordx4 v14, s[20:23], s43 offen lds
    s_add_u32 s43, s43, 7168
    buffer_load_dwordx4 v14, s[20:23], s43 offen offset:1024 lds
    v_exp_f32 v22, v22
    v_exp_f32 v23, v23
    v_mfma_f32_32x32x16_bf16 v[32:47], v[52:55], v[48:51], v[80:95]
    v_exp_f32 v24, v24
    ds_read_b128 v[52:55], v7 offset:20480
    v_exp_f32 v25, v25
    v_exp_f32 v26, v26
    v_exp_f32 v27, v27
    v_smfmac_f32_32x32x32_bf16 v[64:79], v[56:59], v[16:23], v15
    v_exp_f32 v28, v28
    s_mov_b64 exec, s[56:57]
    ds_read_b128 v[56:59], v12 offset:17408
    s_mov_b64 exec, -1
    v_exp_f32 v29, v29
    v_exp_f32 v30, v30
    v_exp_f32 v31, v31
    s_cbranch_vccz KF_PP9
    s_setprio 1
KF_PP9:
    v_exp_f32 v32, v32
    v_exp_f32 v33, v33
    v_exp_f32 v34, v34
    v_exp_f32 v35, v35
    s_waitcnt lgkmcnt(0)
    v_smfmac_f32_32x32x32_bf16 v[64:79], v[60:63], v[24:31], v15
    v_exp_f32 v36, v36
    s_mov_b64 exec, s[56:57]
    ds_read_b128 v[60:63], v12 offset:17920
    s_mov_b64 exec, -1
    v_exp_f32 v37, v37
    s_add_u32 m0, s69, 2048
    s_add_u32 s43, s43, 123904
    buffer_load_dwordx4 v14, s[20:23], s43 offen lds
    s_add_u32 s43, s43, 7168
    buffer_load_dwordx4 v14, s[20:23], s43 offen offset:1024 lds
    v_exp_f32 v38, v38
    v_exp_f32 v39, v39
    v_mfma_f32_32x32x16_bf16 v[16:31], v[52:55], v[48:51], v[80:95]
    v_exp_f32 v40, v40
    ds_read_b128 v[52:55], v7 offset:21504
    v_exp_f32 v41, v41
    v_exp_f32 v42, v42
    v_exp_f32 v43, v43
    v_smfmac_f32_32x32x32_bf16 v[64:79], v[56:59], v[32:39], v15
    v_exp_f32 v44, v44
    s_mov_b64 exec, s[56:57]
    ds_read_b128 v[56:59], v12 offset:20480
    s_mov_b64 exec, -1
    v_exp_f32 v45, v45
    v_exp_f32 v46, v46
    v_exp_f32 v47, v47
    v_exp_f32 v16, v16
    v_exp_f32 v17, v17
    v_exp_f32 v18, v18
    v_exp_f32 v19, v19
    s_waitcnt lgkmcnt(0)
    v_smfmac_f32_32x32x32_bf16 v[64:79], v[60:63], v[40:47], v15
    v_exp_f32 v20, v20
    s_mov_b64 exec, s[56:57]
    ds_read_b128 v[60:63], v12 offset:20992
    s_mov_b64 exec, -1
    v_exp_f32 v21, v21
    v_exp_f32 v22, v22
    v_exp_f32 v23, v23
    v_mfma_f32_32x32x16_bf16 v[32:47], v[52:55], v[48:51], v[80:95]
    v_exp_f32 v24, v24
    ds_read_b128 v[52:55], v7 offset:24576
    v_exp_f32 v25, v25
    v_exp_f32 v26, v26
    v_exp_f32 v27, v27
    v_smfmac_f32_32x32x32_bf16 v[64:79], v[56:59], v[16:23], v15
    v_exp_f32 v28, v28
    s_mov_b64 exec, s[56:57]
    ds_read_b128 v[56:59], v12 offset:21504
    s_mov_b64 exec, -1
    v_exp_f32 v29, v29
    v_exp_f32 v30, v30
    v_exp_f32 v31, v31
    s_cbranch_vccz KF_PP11
    s_setprio 0
KF_PP11:
    v_exp_f32 v32, v32
    v_exp_f32 v33, v33
    v_exp_f32 v34, v34
    v_exp_f32 v35, v35
    s_waitcnt lgkmcnt(0)
    v_smfmac_f32_32x32x32_bf16 v[64:79], v[60:63], v[24:31], v15
    v_exp_f32 v36, v36
    s_mov_b64 exec, s[56:57]
    ds_read_b128 v[60:63], v12 offset:22016
    s_mov_b64 exec, -1
    v_exp_f32 v37, v37
    v_exp_f32 v38, v38
    v_exp_f32 v39, v39
    v_mfma_f32_32x32x16_bf16 v[16:31], v[52:55], v[48:51], v[80:95]
    v_exp_f32 v40, v40
    ds_read_b128 v[52:55], v7 offset:25600
    v_exp_f32 v41, v41
    v_exp_f32 v42, v42
    v_exp_f32 v43, v43
    v_smfmac_f32_32x32x32_bf16 v[64:79], v[56:59], v[32:39], v15
    v_exp_f32 v44, v44
    s_mov_b64 exec, s[56:57]
    ds_read_b128 v[56:59], v12 offset:24576
    s_mov_b64 exec, -1
    v_exp_f32 v45, v45
    v_exp_f32 v46, v46
    v_exp_f32 v47, v47
    s_cbranch_vccz KF_PP12
    s_setprio 1
KF_PP12:
    v_exp_f32 v16, v16
    v_exp_f32 v17, v17
    buffer_load_dword v129, v14, s[24:27], s75 offen
    v_exp_f32 v18, v18
    v_exp_f32 v19, v19
    s_waitcnt lgkmcnt(0)
    v_smfmac_f32_32x32x32_bf16 v[64:79], v[60:63], v[40:47], v15
    v_exp_f32 v20, v20
    s_mov_b64 exec, s[56:57]
    ds_read_b128 v[60:63], v12 offset:25088
    s_mov_b64 exec, -1
    v_exp_f32 v21, v21
    v_exp_f32 v22, v22
    v_exp_f32 v23, v23
    v_mfma_f32_32x32x16_bf16 v[32:47], v[52:55], v[48:51], v[80:95]
    v_exp_f32 v24, v24
    ds_read_b128 v[52:55], v7 offset:28672
    v_exp_f32 v25, v25
    v_exp_f32 v26, v26
    v_exp_f32 v27, v27
    v_smfmac_f32_32x32x32_bf16 v[64:79], v[56:59], v[16:23], v15
    v_exp_f32 v28, v28
    s_mov_b64 exec, s[56:57]
    ds_read_b128 v[56:59], v12 offset:25600
    s_mov_b64 exec, -1
    v_exp_f32 v29, v29
    v_exp_f32 v30, v30
    v_exp_f32 v31, v31
    v_exp_f32 v32, v32
    v_exp_f32 v33, v33
    s_add_u32 s75, s75, 8192
    buffer_load_dword v129, v14, s[24:27], s75 offen
    v_exp_f32 v34, v34
    v_exp_f32 v35, v35
    s_waitcnt lgkmcnt(0)
    v_smfmac_f32_32x32x32_bf16 v[64:79], v[60:63], v[24:31], v15
    v_exp_f32 v36, v36
    s_mov_b64 exec, s[56:57]
    ds_read_b128 v[60:63], v12 offset:26112
    s_mov_b64 exec, -1
    v_exp_f32 v37, v37
    v_exp_f32 v38, v38
    v_exp_f32 v39, v39
    v_mfma_f32_32x32x16_bf16 v[16:31], v[52:55], v[48:51], v[80:95]
    v_exp_f32 v40, v40
    ds_read_b128 v[52:55], v7 offset:29696
    v_exp_f32 v41, v41
    v_exp_f32 v42, v42
    v_exp_f32 v43, v43
    v_smfmac_f32_32x32x32_bf16 v[64:79], v[56:59], v[32:39], v15
    v_exp_f32 v44, v44
    s_mov_b64 exec, s[56:57]
    ds_read_b128 v[56:59], v12 offset:28672
    s_mov_b64 exec, -1
    v_exp_f32 v45, v45
    v_exp_f32 v46, v46
    v_exp_f32 v47, v47
    s_cbranch_vccz KF_PP14
    s_setprio 0
KF_PP14:
    v_exp_f32 v16, v16
    v_exp_f32 v17, v17
    v_exp_f32 v18, v18
    v_exp_f32 v19, v19
    s_waitcnt lgkmcnt(0)
    v_smfmac_f32_32x32x32_bf16 v[64:79], v[60:63], v[40:47], v15
    v_exp_f32 v20, v20
    s_mov_b64 exec, s[56:57]
    ds_read_b128 v[60:63], v12 offset:29184
    s_mov_b64 exec, -1
    v_exp_f32 v21, v21
    v_exp_f32 v22, v22
    v_exp_f32 v23, v23
    v_mfma_f32_32x32x16_bf16 v[32:47], v[52:55], v[48:51], v[80:95]
    v_exp_f32 v24, v24
    ds_read_b128 v[52:55], v7 offset:32768
    v_exp_f32 v25, v25
    v_exp_f32 v26, v26
    v_exp_f32 v27, v27
    v_smfmac_f32_32x32x32_bf16 v[64:79], v[56:59], v[16:23], v15
    v_exp_f32 v28, v28
    s_mov_b64 exec, s[56:57]
    ds_read_b128 v[56:59], v12 offset:29696
    s_mov_b64 exec, -1
    v_exp_f32 v29, v29
    v_exp_f32 v30, v30
    v_exp_f32 v31, v31
    s_cbranch_vccz KF_PP15
    s_setprio 1
KF_PP15:
    v_exp_f32 v32, v32
    v_exp_f32 v33, v33
    v_exp_f32 v34, v34
    v_exp_f32 v35, v35
    s_waitcnt lgkmcnt(0)
    v_smfmac_f32_32x32x32_bf16 v[64:79], v[60:63], v[24:31], v15
    v_exp_f32 v36, v36
    s_mov_b64 exec, s[56:57]
    ds_read_b128 v[60:63], v12 offset:30208
    s_mov_b64 exec, -1
    v_exp_f32 v37, v37
    v_exp_f32 v38, v38
    v_exp_f32 v39, v39
    v_mfma_f32_32x32x16_bf16 v[16:31], v[52:55], v[48:51], v[80:95]
    v_exp_f32 v40, v40
    ds_read_b128 v[52:55], v7 offset:33792
    v_exp_f32 v41, v41
    v_exp_f32 v42, v42
    v_exp_f32 v43, v43
    v_smfmac_f32_32x32x32_bf16 v[64:79], v[56:59], v[32:39], v15
    v_exp_f32 v44, v44
    s_mov_b64 exec, s[56:57]
    ds_read_b128 v[56:59], v12 offset:32768
    s_mov_b64 exec, -1
    v_exp_f32 v45, v45
    v_exp_f32 v46, v46
    v_exp_f32 v47, v47
    v_exp_f32 v16, v16
    v_exp_f32 v17, v17
    v_exp_f32 v18, v18
    v_exp_f32 v19, v19
    s_waitcnt lgkmcnt(0)
    v_smfmac_f32_32x32x32_bf16 v[64:79], v[60:63], v[40:47], v15
    v_exp_f32 v20, v20
    s_mov_b64 exec, s[56:57]
    ds_read_b128 v[60:63], v12 offset:33280
    s_mov_b64 exec, -1
    v_exp_f32 v21, v21
    v_exp_f32 v22, v22
    v_exp_f32 v23, v23
    v_mfma_f32_32x32x16_bf16 v[32:47], v[52:55], v[48:51], v[80:95]
    v_exp_f32 v24, v24
    ds_read_b128 v[52:55], v7 offset:36864
    v_exp_f32 v25, v25
    v_exp_f32 v26, v26
    v_exp_f32 v27, v27
    v_smfmac_f32_32x32x32_bf16 v[64:79], v[56:59], v[16:23], v15
    v_exp_f32 v28, v28
    s_mov_b64 exec, s[56:57]
    ds_read_b128 v[56:59], v12 offset:33792
    s_mov_b64 exec, -1
    v_exp_f32 v29, v29
    v_exp_f32 v30, v30
    v_exp_f32 v31, v31
    s_cbranch_vccz KF_PP17
    s_setprio 0
KF_PP17:
    v_exp_f32 v32, v32
    v_exp_f32 v33, v33
    v_exp_f32 v34, v34
    v_exp_f32 v35, v35
    s_waitcnt lgkmcnt(0)
    v_smfmac_f32_32x32x32_bf16 v[64:79], v[60:63], v[24:31], v15
    v_exp_f32 v36, v36
    s_mov_b64 exec, s[56:57]
    ds_read_b128 v[60:63], v12 offset:34304
    s_mov_b64 exec, -1
    v_exp_f32 v37, v37
    v_exp_f32 v38, v38
    v_exp_f32 v39, v39
    v_mfma_f32_32x32x16_bf16 v[16:31], v[52:55], v[48:51], v[80:95]
    v_exp_f32 v40, v40
    ds_read_b128 v[52:55], v7 offset:37888
    v_exp_f32 v41, v41
    v_exp_f32 v42, v42
    v_exp_f32 v43, v43
    v_smfmac_f32_32x32x32_bf16 v[64:79], v[56:59], v[32:39], v15
    v_exp_f32 v44, v44
    s_mov_b64 exec, s[56:57]
    ds_read_b128 v[56:59], v12 offset:36864
    s_mov_b64 exec, -1
    v_exp_f32 v45, v45
    v_exp_f32 v46, v46
    v_exp_f32 v47, v47
    s_cbranch_vccz KF_PP18
    s_setprio 1
KF_PP18:
    v_exp_f32 v16, v16
    buffer_load_dword v8, v1, s[4:7], s51 offen sc1
    buffer_load_dword v9, v1, s[4:7], s52 offen sc1
    buffer_load_dword v3, v1, s[4:7], s53 offen sc1
    v_exp_f32 v17, v17
    v_exp_f32 v18, v18
    v_exp_f32 v19, v19
    s_waitcnt lgkmcnt(0)
    v_smfmac_f32_32x32x32_bf16 v[64:79], v[60:63], v[40:47], v15
    v_exp_f32 v20, v20
    s_mov_b64 exec, s[56:57]
    ds_read_b128 v[60:63], v12 offset:37376
    s_mov_b64 exec, -1
    v_exp_f32 v21, v21
    v_exp_f32 v22, v22
    v_exp_f32 v23, v23
    v_mfma_f32_32x32x16_bf16 v[32:47], v[52:55], v[48:51], v[80:95]
    v_exp_f32 v24, v24
    ds_read_b128 v[52:55], v7 offset:40960
    v_exp_f32 v25, v25
    v_exp_f32 v26, v26
    v_exp_f32 v27, v27
    v_smfmac_f32_32x32x32_bf16 v[64:79], v[56:59], v[16:23], v15
    v_exp_f32 v28, v28
    s_mov_b64 exec, s[56:57]
    ds_read_b128 v[56:59], v12 offset:37888
    s_mov_b64 exec, -1
    v_exp_f32 v29, v29
    v_exp_f32 v30, v30
    v_exp_f32 v31, v31
    v_exp_f32 v32, v32
    v_exp_f32 v33, v33
    v_exp_f32 v34, v34
    v_exp_f32 v35, v35
    s_waitcnt lgkmcnt(0)
    v_smfmac_f32_32x32x32_bf16 v[64:79], v[60:63], v[24:31], v15
    v_exp_f32 v36, v36
    s_mov_b64 exec, s[56:57]
    ds_read_b128 v[60:63], v12 offset:38400
    s_mov_b64 exec, -1
    v_exp_f32 v37, v37
    v_exp_f32 v38, v38
    v_exp_f32 v39, v39
    v_mfma_f32_32x32x16_bf16 v[16:31], v[52:55], v[48:51], v[80:95]
    v_exp_f32 v40, v40
    ds_read_b128 v[52:55], v7 offset:41984
    v_exp_f32 v41, v41
    v_exp_f32 v42, v42
    v_exp_f32 v43, v43
    v_smfmac_f32_32x32x32_bf16 v[64:79], v[56:59], v[32:39], v15
    v_exp_f32 v44, v44
    s_mov_b64 exec, s[56:57]
    ds_read_b128 v[56:59], v12 offset:40960
    s_mov_b64 exec, -1
    v_exp_f32 v45, v45
    v_exp_f32 v46, v46
    v_exp_f32 v47, v47
    s_cbranch_vccz KF_PP20
    s_setprio 0
KF_PP20:
    v_exp_f32 v16, v16
    v_exp_f32 v17, v17
    v_exp_f32 v18, v18
    v_exp_f32 v19, v19
    s_waitcnt lgkmcnt(0)
    v_smfmac_f32_32x32x32_bf16 v[64:79], v[60:63], v[40:47], v15
    v_exp_f32 v20, v20
    s_mov_b64 exec, s[56:57]
    ds_read_b128 v[60:63], v12 offset:41472
    s_mov_b64 exec, -1
    v_exp_f32 v21, v21
    v_exp_f32 v22, v22
    v_exp_f32 v23, v23
    v_mfma_f32_32x32x16_bf16 v[32:47], v[52:55], v[48:51], v[80:95]
    v_exp_f32 v24, v24
    ds_read_b128 v[52:55], v7 offset:45056
    v_exp_f32 v25, v25
    v_exp_f32 v26, v26
    v_exp_f32 v27, v27
    v_smfmac_f32_32x32x32_bf16 v[64:79], v[56:59], v[16:23], v15
    v_exp_f32 v28, v28
    s_mov_b64 exec, s[56:57]
    ds_read_b128 v[56:59], v12 offset:41984
    s_mov_b64 exec, -1
    v_exp_f32 v29, v29
    v_exp_f32 v30, v30
    v_exp_f32 v31, v31
    s_cbranch_vccz KF_PP21
    s_setprio 1
KF_PP21:
    v_exp_f32 v32, v32
    v_exp_f32 v33, v33
    v_exp_f32 v34, v34
    v_exp_f32 v35, v35
    s_waitcnt lgkmcnt(0)
    v_smfmac_f32_32x32x32_bf16 v[64:79], v[60:63], v[24:31], v15
    v_exp_f32 v36, v36
    s_mov_b64 exec, s[56:57]
    ds_read_b128 v[60:63], v12 offset:42496
    s_mov_b64 exec, -1
    v_exp_f32 v37, v37
    v_exp_f32 v38, v38
    v_exp_f32 v39, v39
    v_mfma_f32_32x32x16_bf16 v[16:31], v[52:55], v[48:51], v[80:95]
    v_exp_f32 v40, v40
    ds_read_b128 v[52:55], v7 offset:46080
    v_exp_f32 v41, v41
    v_exp_f32 v42, v42
    v_exp_f32 v43, v43
    v_smfmac_f32_32x32x32_bf16 v[64:79], v[56:59], v[32:39], v15
    v_exp_f32 v44, v44
    s_mov_b64 exec, s[56:57]
    ds_read_b128 v[56:59], v12 offset:45056
    s_mov_b64 exec, -1
    v_exp_f32 v45, v45
    v_exp_f32 v46, v46
    v_exp_f32 v47, v47
    v_exp_f32 v16, v16
    s_waitcnt vmcnt(0)
    v_max3_u32 v6, v8, v9, v3
    v_cmp_eq_u32 s[62:63], -1, v6
    s_cmp_lg_u64 s[62:63], 0
    s_cbranch_scc1 GC_SP
GC_OK:
    v_lshl_add_u32 v6, v2, 7, s59
    v_min_u32 v6, 176000, v6
    s_mov_b64 exec, 4194303
    buffer_load_dword v3, v6, s[4:7], s55 offen sc1
    s_mov_b64 exec, -1
    v_exp_f32 v17, v17
    v_exp_f32 v18, v18
    v_exp_f32 v19, v19
    s_waitcnt lgkmcnt(0)
    v_smfmac_f32_32x32x32_bf16 v[64:79], v[60:63], v[40:47], v15
    v_exp_f32 v20, v20
    s_mov_b64 exec, s[56:57]
    ds_read_b128 v[60:63], v12 offset:45568
    s_mov_b64 exec, -1
    v_exp_f32 v21, v21
    v_exp_f32 v22, v22
    v_exp_f32 v23, v23
    v_mfma_f32_32x32x16_bf16 v[32:47], v[52:55], v[48:51], v[80:95]
    v_exp_f32 v24, v24
    ds_read_b128 v[52:55], v7 offset:49152
    v_exp_f32 v25, v25
    v_exp_f32 v26, v26
    v_exp_f32 v27, v27
    v_smfmac_f32_32x32x32_bf16 v[64:79], v[56:59], v[16:23], v15
    v_exp_f32 v28, v28
    s_mov_b64 exec, s[56:57]
    ds_read_b128 v[56:59], v12 offset:46080
    s_mov_b64 exec, -1
    v_exp_f32 v29, v29
    v_exp_f32 v30, v30
    v_exp_f32 v31, v31
    s_cbranch_vccz KF_PP23
    s_setprio 0
KF_PP23:
    v_exp_f32 v32, v32
    buffer_load_dwordx4 v[172:175], v10, s[4:7], s45 offen sc1
    v_exp_f32 v33, v33
    buffer_load_dwordx4 v[168:171], v10, s[4:7], s44 offen sc1
    v_exp_f32 v34, v34
    v_exp_f32 v35, v35
    s_waitcnt lgkmcnt(0)
    v_smfmac_f32_32x32x32_bf16 v[64:79], v[60:63], v[24:31], v15
    v_exp_f32 v36, v36
    s_mov_b64 exec, s[56:57]
    ds_read_b128 v[60:63], v12 offset:46592
    s_mov_b64 exec, -1
    v_exp_f32 v37, v37
    v_exp_f32 v38, v38
    v_exp_f32 v39, v39
    v_mfma_f32_32x32x16_bf16 v[16:31], v[52:55], v[48:51], v[80:95]
    v_exp_f32 v40, v40
    ds_read_b128 v[52:55], v7 offset:50176
    v_exp_f32 v41, v41
    v_exp_f32 v42, v42
    v_exp_f32 v43, v43
    v_smfmac_f32_32x32x32_bf16 v[64:79], v[56:59], v[32:39], v15
    v_exp_f32 v44, v44
    s_mov_b64 exec, s[56:57]
    ds_read_b128 v[56:59], v12 offset:49152
    s_mov_b64 exec, -1
    v_exp_f32 v45, v45
    v_exp_f32 v46, v46
    v_exp_f32 v47, v47
    s_cbranch_vccz KF_PP24
    s_setprio 1
KF_PP24:
    v_exp_f32 v16, v16
    s_add_u32 s45, s45, 8192
    buffer_load_dwordx4 v[180:183], v10, s[4:7], s45 offen sc1
    v_exp_f32 v17, v17
    s_add_u32 s44, s44, 8192
    buffer_load_dwordx4 v[176:179], v10, s[4:7], s44 offen sc1
    v_exp_f32 v18, v18
    v_exp_f32 v19, v19
    s_waitcnt lgkmcnt(0)
    v_smfmac_f32_32x32x32_bf16 v[64:79], v[60:63], v[40:47], v15
    v_exp_f32 v20, v20
    s_mov_b64 exec, s[56:57]
    ds_read_b128 v[60:63], v12 offset:49664
    s_mov_b64 exec, -1
    v_exp_f32 v21, v21
    v_exp_f32 v22, v22
    s_waitcnt vmcnt(15)
    s_barrier
    v_exp_f32 v23, v23
    v_mfma_f32_32x32x16_bf16 v[32:47], v[52:55], v[48:51], v[80:95]
    v_exp_f32 v24, v24
    ds_read_b128 v[52:55], v7 offset:53248
    v_exp_f32 v25, v25
    v_exp_f32 v26, v26
    v_exp_f32 v27, v27
    v_smfmac_f32_32x32x32_bf16 v[64:79], v[56:59], v[16:23], v15
    v_exp_f32 v28, v28
    s_mov_b64 exec, s[56:57]
    ds_read_b128 v[56:59], v12 offset:50176
    s_mov_b64 exec, -1
    v_exp_f32 v29, v29
    v_exp_f32 v30, v30
    v_exp_f32 v31, v31
    v_exp_f32 v32, v32
    s_add_u32 s45, s45, 8192
    buffer_load_dwordx4 v[188:191], v10, s[4:7], s45 offen sc1
    v_exp_f32 v33, v33
    s_add_u32 s44, s44, 8192
    buffer_load_dwordx4 v[184:187], v10, s[4:7], s44 offen sc1
    v_exp_f32 v34, v34
    v_exp_f32 v35, v35
    s_waitcnt lgkmcnt(0)
    v_smfmac_f32_32x32x32_bf16 v[64:79], v[60:63], v[24:31], v15
    v_exp_f32 v36, v36
    s_mov_b64 exec, s[56:57]
    ds_read_b128 v[60:63], v12 offset:50688
    s_mov_b64 exec, -1
    v_exp_f32 v37, v37
    v_exp_f32 v38, v38
    v_exp_f32 v39, v39
    v_mfma_f32_32x32x16_bf16 v[16:31], v[52:55], v[48:51], v[80:95]
    v_exp_f32 v40, v40
    ds_read_b128 v[52:55], v7 offset:54272
    v_exp_f32 v41, v41
    s_waitcnt vmcnt(14)
    ds_read_b64_tr_b16 v[160:161], v4 offset:0
    ds_read_b64_tr_b16 v[162:163], v4 offset:512
    v_exp_f32 v42, v42
    ds_read_b64_tr_b16 v[164:165], v5 offset:0
    ds_read_b64_tr_b16 v[166:167], v5 offset:512
    v_exp_f32 v43, v43
    v_smfmac_f32_32x32x32_bf16 v[64:79], v[56:59], v[32:39], v15
    v_exp_f32 v44, v44
    s_mov_b64 exec, s[56:57]
    ds_read_b128 v[56:59], v12 offset:53248
    s_mov_b64 exec, -1
    v_exp_f32 v45, v45
    v_exp_f32 v46, v46
    v_exp_f32 v47, v47
    s_cbranch_vccz KF_PP26
    s_setprio 0
KF_PP26:
    v_exp_f32 v16, v16
    v_exp_f32 v17, v17
    v_exp_f32 v18, v18
    v_exp_f32 v19, v19
    s_waitcnt lgkmcnt(0)
    v_smfmac_f32_32x32x32_bf16 v[64:79], v[60:63], v[40:47], v15
    v_exp_f32 v20, v20
    s_mov_b64 exec, s[56:57]
    ds_read_b128 v[60:63], v12 offset:53760
    s_mov_b64 exec, -1
    v_exp_f32 v21, v21
    s_add_u32 m0, s69, 0
    s_add_u32 s43, s43, 123904
    buffer_load_dwordx4 v14, s[20:23], s43 offen lds
    s_add_u32 s43, s43, 7168
    buffer_load_dwordx4 v14, s[20:23], s43 offen offset:1024 lds
    v_exp_f32 v22, v22
    s_add_u32 m0, s69, 32768
    s_nop 0
    buffer_load_dwordx4 v14, s[24:27], s42 offen lds
    s_add_u32 s42, s42, 7168
    buffer_load_dwordx4 v14, s[24:27], s42 offen offset:1024 lds
    v_exp_f32 v23, v23
    v_mfma_f32_32x32x16_bf16 v[32:47], v[52:55], v[48:51], v[80:95]
    v_exp_f32 v24, v24
    ds_read_b128 v[52:55], v7 offset:57344
    v_exp_f32 v25, v25
    v_exp_f32 v26, v26
    v_exp_f32 v27, v27
    v_smfmac_f32_32x32x32_bf16 v[64:79], v[56:59], v[16:23], v15
    v_exp_f32 v28, v28
    s_mov_b64 exec, s[56:57]
    ds_read_b128 v[56:59], v12 offset:54272
    s_mov_b64 exec, -1
    v_exp_f32 v29, v29
    v_exp_f32 v30, v30
    v_exp_f32 v31, v31
    s_cbranch_vccz KF_PP27
    s_setprio 1
KF_PP27:
    v_exp_f32 v32, v32
    v_exp_f32 v33, v33
    v_exp_f32 v34, v34
    v_exp_f32 v35, v35
    s_waitcnt lgkmcnt(0)
    v_smfmac_f32_32x32x32_bf16 v[64:79], v[60:63], v[24:31], v15
    v_exp_f32 v36, v36
    s_mov_b64 exec, s[56:57]
    ds_read_b128 v[60:63], v12 offset:54784
    s_mov_b64 exec, -1
    v_exp_f32 v37, v37
    v_exp_f32 v38, v38
    s_add_u32 m0, s69, 34816
    s_add_u32 s42, s42, 9216
    buffer_load_dwordx4 v14, s[24:27], s42 offen lds
    s_add_u32 s42, s42, 7168
    buffer_load_dwordx4 v14, s[24:27], s42 offen offset:1024 lds
    v_exp_f32 v39, v39
    v_mfma_f32_32x32x16_bf16 v[16:31], v[52:55], v[48:51], v[80:95]
    v_exp_f32 v40, v40
    ds_read_b128 v[52:55], v7 offset:58368
    v_exp_f32 v41, v41
    v_exp_f32 v42, v42
    v_exp_f32 v43, v43
    v_smfmac_f32_32x32x32_bf16 v[64:79], v[56:59], v[32:39], v15
    v_exp_f32 v44, v44
    s_mov_b64 exec, s[56:57]
    ds_read_b128 v[56:59], v12 offset:57344
    s_mov_b64 exec, -1
    v_exp_f32 v45, v45
    v_exp_f32 v46, v46
    v_exp_f32 v47, v47
    s_waitcnt vmcnt(11)
    v_mfma_f32_32x32x16_bf16 v[128:143], v[160:163], v[172:175], 0
    v_exp_f32 v16, v16
    v_exp_f32 v17, v17
    v_exp_f32 v18, v18
    v_exp_f32 v19, v19
    s_waitcnt lgkmcnt(0)
    v_smfmac_f32_32x32x32_bf16 v[64:79], v[60:63], v[40:47], v15
    v_exp_f32 v20, v20
    s_mov_b64 exec, s[56:57]
    ds_read_b128 v[60:63], v12 offset:57856
    s_mov_b64 exec, -1
    v_exp_f32 v21, v21
    v_exp_f32 v22, v22
    v_exp_f32 v23, v23
    v_mfma_f32_32x32x16_bf16 v[32:47], v[52:55], v[48:51], v[80:95]
    v_exp_f32 v24, v24
    ds_read_b128 v[52:55], v7 offset:61440
    v_exp_f32 v25, v25
    v_exp_f32 v26, v26
    v_exp_f32 v27, v27
    v_smfmac_f32_32x32x32_bf16 v[64:79], v[56:59], v[16:23], v15
    v_exp_f32 v28, v28
    s_mov_b64 exec, s[56:57]
    ds_read_b128 v[56:59], v12 offset:58368
    s_mov_b64 exec, -1
    v_exp_f32 v29, v29
    v_exp_f32 v30, v30
    v_exp_f32 v31, v31
    s_waitcnt vmcnt(10)
    v_mfma_f32_32x32x16_bf16 v[96:111], v[160:163], v[168:171], 0
    s_cbranch_vccz KF_PP29
    s_setprio 0
KF_PP29:
    v_exp_f32 v32, v32
    v_exp_f32 v33, v33
    v_exp_f32 v34, v34
    v_exp_f32 v35, v35
    s_waitcnt lgkmcnt(0)
    v_smfmac_f32_32x32x32_bf16 v[64:79], v[60:63], v[24:31], v15
    v_exp_f32 v36, v36
    s_mov_b64 exec, s[56:57]
    ds_read_b128 v[60:63], v12 offset:58880
    s_mov_b64 exec, -1
    v_exp_f32 v37, v37
    v_exp_f32 v38, v38
    v_exp_f32 v39, v39
    v_mfma_f32_32x32x16_bf16 v[16:31], v[52:55], v[48:51], v[80:95]
    v_exp_f32 v40, v40
    ds_read_b128 v[52:55], v7 offset:62464
    v_exp_f32 v41, v41
    s_waitcnt vmcnt(18)
    ds_read_b64_tr_b16 v[160:161], v4 offset:2048
    ds_read_b64_tr_b16 v[162:163], v4 offset:2560
    v_exp_f32 v42, v42
    v_exp_f32 v43, v43
    v_smfmac_f32_32x32x32_bf16 v[64:79], v[56:59], v[32:39], v15
    v_exp_f32 v44, v44
    s_mov_b64 exec, s[56:57]
    ds_read_b128 v[56:59], v12 offset:61440
    s_mov_b64 exec, -1
    v_exp_f32 v45, v45
    v_exp_f32 v46, v46
    v_exp_f32 v47, v47
    v_mfma_f32_32x32x16_bf16 v[144:159], v[164:167], v[172:175], 0
    s_cbranch_vccz KF_PP30
    s_setprio 1
KF_PP30:
    v_exp_f32 v16, v16
    s_add_u32 s45, s45, 8192
    buffer_load_dwordx4 v[172:175], v10, s[4:7], s45 offen sc1
    v_exp_f32 v17, v17
    v_exp_f32 v18, v18
    v_exp_f32 v19, v19
    s_waitcnt lgkmcnt(0)
    v_smfmac_f32_32x32x32_bf16 v[64:79], v[60:63], v[40:47], v15
    v_exp_f32 v20, v20
    s_mov_b64 exec, s[56:57]
    ds_read_b128 v[60:63], v12 offset:61952
    s_mov_b64 exec, -1
    v_exp_f32 v21, v21
    v_exp_f32 v22, v22
    v_exp_f32 v23, v23
    v_mfma_f32_32x32x16_bf16 v[32:47], v[52:55], v[48:51], v[80:95]
    v_exp_f32 v24, v24
    ds_read_b128 v[52:55], v11 offset:0
    v_exp_f32 v25, v25
    v_exp_f32 v26, v26
    v_exp_f32 v27, v27
    v_smfmac_f32_32x32x32_bf16 v[64:79], v[56:59], v[16:23], v15
    v_exp_f32 v28, v28
    s_mov_b64 exec, s[56:57]
    ds_read_b128 v[56:59], v12 offset:62464
    s_mov_b64 exec, -1
    v_exp_f32 v29, v29
    s_waitcnt vmcnt(3)
    ds_read_b64_tr_b16 v[192:193], v4 offset:32768
    ds_read_b64_tr_b16 v[194:195], v4 offset:33280
    v_exp_f32 v30, v30
    ds_read_b64_tr_b16 v[196:197], v5 offset:32768
    ds_read_b64_tr_b16 v[198:199], v5 offset:33280
    v_exp_f32 v31, v31
    v_mfma_f32_32x32x16_bf16 v[112:127], v[164:167], v[168:171], 0
    v_exp_f32 v32, v32
    s_add_u32 s44, s44, 8192
    buffer_load_dwordx4 v[168:171], v10, s[4:7], s44 offen sc1
    v_exp_f32 v33, v33
    v_exp_f32 v34, v34
    v_exp_f32 v35, v35
    s_waitcnt lgkmcnt(0)
    v_smfmac_f32_32x32x32_bf16 v[64:79], v[60:63], v[24:31], v15
    v_exp_f32 v36, v36
    s_mov_b64 exec, s[56:57]
    ds_read_b128 v[60:63], v12 offset:62976
    s_mov_b64 exec, -1
    v_exp_f32 v37, v37
    v_exp_f32 v38, v38
    s_add_u32 m0, s69, 32768
    s_add_u32 s42, s42, 9216
    buffer_load_dwordx4 v14, s[24:27], s42 offen lds
    s_add_u32 s42, s42, 7168
    buffer_load_dwordx4 v14, s[24:27], s42 offen offset:1024 lds
    v_exp_f32 v39, v39
    v_mfma_f32_32x32x16_bf16 v[16:31], v[52:55], v[48:51], v[80:95]
    v_exp_f32 v40, v40
    ds_read_b128 v[52:55], v11 offset:1024
    v_exp_f32 v41, v41
    ds_read_b64_tr_b16 v[164:165], v5 offset:2048
    ds_read_b64_tr_b16 v[166:167], v5 offset:2560
    v_exp_f32 v42, v42
    v_exp_f32 v43, v43
    v_smfmac_f32_32x32x32_bf16 v[64:79], v[56:59], v[32:39], v15
    v_exp_f32 v44, v44
    s_mov_b64 exec, s[56:57]
    ds_read_b128 v[56:59], v13 offset:0
    s_mov_b64 exec, -1
    v_exp_f32 v45, v45
    v_exp_f32 v46, v46
    v_exp_f32 v47, v47
    s_waitcnt vmcnt(13)
    v_mfma_f32_32x32x16_bf16 v[128:143], v[160:163], v[180:183], v[128:143]
    s_cbranch_vccz KF_PP32
    s_setprio 0
KF_PP32:
    v_exp_f32 v16, v16
    v_exp_f32 v17, v17
    v_exp_f32 v18, v18
    v_exp_f32 v19, v19
    s_waitcnt lgkmcnt(0)
    v_smfmac_f32_32x32x32_bf16 v[64:79], v[60:63], v[40:47], v15
    v_exp_f32 v20, v20
    s_mov_b64 exec, s[56:57]
    ds_read_b128 v[60:63], v13 offset:512
    s_mov_b64 exec, -1
    v_exp_f32 v21, v21
    s_add_u32 m0, s69, 2048
    s_add_u32 s43, s43, 123904
    buffer_load_dwordx4 v14, s[20:23], s43 offen lds
    s_add_u32 s43, s43, 7168
    buffer_load_dwordx4 v14, s[20:23], s43 offen offset:1024 lds
    v_exp_f32 v22, v22
    v_exp_f32 v23, v23
    v_mfma_f32_32x32x16_bf16 v[32:47], v[52:55], v[48:51], v[80:95]
    v_exp_f32 v24, v24
    ds_read_b128 v[52:55], v11 offset:4096
    v_exp_f32 v25, v25
    v_exp_f32 v26, v26
    v_exp_f32 v27, v27
    v_smfmac_f32_32x32x32_bf16 v[64:79], v[56:59], v[16:23], v15
    v_exp_f32 v28, v28
    s_mov_b64 exec, s[56:57]
    ds_read_b128 v[56:59], v13 offset:1024
    s_mov_b64 exec, -1
    v_exp_f32 v29, v29
    v_exp_f32 v30, v30
    v_exp_f32 v31, v31
    s_waitcnt vmcnt(14)
    v_mfma_f32_32x32x16_bf16 v[96:111], v[160:163], v[176:179], v[96:111]
    s_cbranch_vccz KF_PP33
    s_setprio 1
KF_PP33:
    v_exp_f32 v32, v32
    v_exp_f32 v33, v33
    v_exp_f32 v34, v34
    v_exp_f32 v35, v35
    s_waitcnt lgkmcnt(0)
    v_smfmac_f32_32x32x32_bf16 v[64:79], v[60:63], v[24:31], v15
    v_exp_f32 v36, v36
    s_mov_b64 exec, s[56:57]
    ds_read_b128 v[60:63], v13 offset:1536
    s_mov_b64 exec, -1
    v_exp_f32 v37, v37
    v_exp_f32 v38, v38
    v_exp_f32 v39, v39
    v_mfma_f32_32x32x16_bf16 v[16:31], v[52:55], v[48:51], v[80:95]
    v_exp_f32 v40, v40
    ds_read_b128 v[52:55], v11 offset:5120
    v_exp_f32 v41, v41
    s_waitcnt vmcnt(10)
    ds_read_b64_tr_b16 v[160:161], v4 offset:0
    ds_read_b64_tr_b16 v[162:163], v4 offset:512
    v_exp_f32 v42, v42
    v_exp_f32 v43, v43
    v_smfmac_f32_32x32x32_bf16 v[64:79], v[56:59], v[32:39], v15
    v_exp_f32 v44, v44
    s_mov_b64 exec, s[56:57]
    ds_read_b128 v[56:59], v13 offset:4096
    s_mov_b64 exec, -1
    v_exp_f32 v45, v45
    v_exp_f32 v46, v46
    v_exp_f32 v47, v47
    v_mfma_f32_32x32x16_bf16 v[144:159], v[164:167], v[180:183], v[144:159]
    v_exp_f32 v16, v16
    s_add_u32 s45, s45, 8192
    buffer_load_dwordx4 v[180:183], v10, s[4:7], s45 offen sc1
    v_exp_f32 v17, v17
    v_exp_f32 v18, v18
    v_exp_f32 v19, v19
    s_waitcnt lgkmcnt(0)
    v_smfmac_f32_32x32x32_bf16 v[64:79], v[60:63], v[40:47], v15
    v_exp_f32 v20, v20
    s_mov_b64 exec, s[56:57]
    ds_read_b128 v[60:63], v13 offset:4608
    s_mov_b64 exec, -1
    v_exp_f32 v21, v21
    v_exp_f32 v22, v22
    v_exp_f32 v23, v23
    v_mfma_f32_32x32x16_bf16 v[32:47], v[52:55], v[48:51], v[80:95]
    v_exp_f32 v24, v24
    ds_read_b128 v[52:55], v11 offset:8192
    v_exp_f32 v25, v25
    v_exp_f32 v26, v26
    v_exp_f32 v27, v27
    v_smfmac_f32_32x32x32_bf16 v[64:79], v[56:59], v[16:23], v15
    v_exp_f32 v28, v28
    s_mov_b64 exec, s[56:57]
    ds_read_b128 v[56:59], v13 offset:5120
    s_mov_b64 exec, -1
    v_exp_f32 v29, v29
    s_waitcnt vmcnt(7)
    ds_read_b64_tr_b16 v[200:201], v4 offset:34816
    ds_read_b64_tr_b16 v[202:203], v4 offset:35328
    v_exp_f32 v30, v30
    ds_read_b64_tr_b16 v[204:205], v5 offset:34816
    ds_read_b64_tr_b16 v[206:207], v5 offset:35328
    v_exp_f32 v31, v31
    v_mfma_f32_32x32x16_bf16 v[112:127], v[164:167], v[176:179], v[112:127]
    s_cbranch_vccz KF_PP35
    s_setprio 0
KF_PP35:
    v_exp_f32 v32, v32
    s_add_u32 s44, s44, 8192
    buffer_load_dwordx4 v[176:179], v10, s[4:7], s44 offen sc1
    v_exp_f32 v33, v33
    v_exp_f32 v34, v34
    v_exp_f32 v35, v35
    s_waitcnt lgkmcnt(0)
    v_smfmac_f32_32x32x32_bf16 v[64:79], v[60:63], v[24:31], v15
    v_exp_f32 v36, v36
    s_mov_b64 exec, s[56:57]
    ds_read_b128 v[60:63], v13 offset:5632
    s_mov_b64 exec, -1
    v_exp_f32 v37, v37
    v_exp_f32 v38, v38
    s_add_u32 m0, s69, 34816
    s_add_u32 s42, s42, 9216
    buffer_load_dwordx4 v14, s[24:27], s42 offen lds
    s_add_u32 s42, s42, 7168
    buffer_load_dwordx4 v14, s[24:27], s42 offen offset:1024 lds
    v_exp_f32 v39, v39
    v_mfma_f32_32x32x16_bf16 v[16:31], v[52:55], v[48:51], v[80:95]
    v_exp_f32 v40, v40
    ds_read_b128 v[52:55], v11 offset:9216
    v_exp_f32 v41, v41
    ds_read_b64_tr_b16 v[164:165], v5 offset:0
    ds_read_b64_tr_b16 v[166:167], v5 offset:512
    v_exp_f32 v42, v42
    v_exp_f32 v43, v43
    v_smfmac_f32_32x32x32_bf16 v[64:79], v[56:59], v[32:39], v15
    v_exp_f32 v44, v44
    s_mov_b64 exec, s[56:57]
    ds_read_b128 v[56:59], v13 offset:8192
    s_mov_b64 exec, -1
    v_exp_f32 v45, v45
    v_exp_f32 v46, v46
    v_exp_f32 v47, v47
    s_waitcnt vmcnt(17)
    v_mfma_f32_32x32x16_bf16 v[128:143], v[160:163], v[188:191], v[128:143]
    s_cbranch_vccz KF_PP36
    s_setprio 1
KF_PP36:
    v_exp_f32 v16, v16
    v_exp_f32 v17, v17
    v_exp_f32 v18, v18
    v_exp_f32 v19, v19
    s_waitcnt lgkmcnt(0)
    v_smfmac_f32_32x32x32_bf16 v[64:79], v[60:63], v[40:47], v15
    v_exp_f32 v20, v20
    s_mov_b64 exec, s[56:57]
    ds_read_b128 v[60:63], v13 offset:8704
    s_mov_b64 exec, -1
    v_exp_f32 v21, v21
    s_add_u32 m0, s69, 0
    s_add_u32 s43, s43, 123904
    buffer_load_dwordx4 v14, s[20:23], s43 offen lds
    s_add_u32 s43, s43, 7168
    buffer_load_dwordx4 v14, s[20:23], s43 offen offset:1024 lds
    v_exp_f32 v22, v22
    v_exp_f32 v23, v23
    v_mfma_f32_32x32x16_bf16 v[32:47], v[52:55], v[48:51], v[80:95]
    v_exp_f32 v24, v24
    ds_read_b128 v[52:55], v11 offset:12288
    v_exp_f32 v25, v25
    v_exp_f32 v26, v26
    v_exp_f32 v27, v27
    v_smfmac_f32_32x32x32_bf16 v[64:79], v[56:59], v[16:23], v15
    v_exp_f32 v28, v28
    s_mov_b64 exec, s[56:57]
    ds_read_b128 v[56:59], v13 offset:9216
    s_mov_b64 exec, -1
    v_exp_f32 v29, v29
    v_exp_f32 v30, v30
    v_exp_f32 v31, v31
    s_waitcnt vmcnt(18)
    v_mfma_f32_32x32x16_bf16 v[96:111], v[160:163], v[184:187], v[96:111]
    v_exp_f32 v32, v32
    v_exp_f32 v33, v33
    v_exp_f32 v34, v34
    v_exp_f32 v35, v35
    s_waitcnt lgkmcnt(0)
    v_smfmac_f32_32x32x32_bf16 v[64:79], v[60:63], v[24:31], v15
    v_exp_f32 v36, v36
    s_mov_b64 exec, s[56:57]
    ds_read_b128 v[60:63], v13 offset:9728
    s_mov_b64 exec, -1
    v_exp_f32 v37, v37
    v_exp_f32 v38, v38
    v_exp_f32 v39, v39
    v_mfma_f32_32x32x16_bf16 v[16:31], v[52:55], v[48:51], v[80:95]
    v_exp_f32 v40, v40
    ds_read_b128 v[52:55], v11 offset:13312
    v_exp_f32 v41, v41
    s_waitcnt vmcnt(6)
    ds_read_b64_tr_b16 v[160:161], v4 offset:2048
    ds_read_b64_tr_b16 v[162:163], v4 offset:2560
    v_exp_f32 v42, v42
    v_exp_f32 v43, v43
    v_smfmac_f32_32x32x32_bf16 v[64:79], v[56:59], v[32:39], v15
    v_exp_f32 v44, v44
    s_mov_b64 exec, s[56:57]
    ds_read_b128 v[56:59], v13 offset:12288
    s_mov_b64 exec, -1
    v_exp_f32 v45, v45
    v_exp_f32 v46, v46
    v_exp_f32 v47, v47
    v_mfma_f32_32x32x16_bf16 v[144:159], v[164:167], v[188:191], v[144:159]
    s_cbranch_vccz KF_PP38
    s_setprio 0
KF_PP38:
    v_exp_f32 v16, v16
    s_add_u32 s45, s45, 8192
    buffer_load_dwordx4 v[188:191], v10, s[4:7], s45 offen sc1
    v_exp_f32 v17, v17
    v_exp_f32 v18, v18
    v_exp_f32 v19, v19
    s_waitcnt lgkmcnt(0)
    v_smfmac_f32_32x32x32_bf16 v[64:79], v[60:63], v[40:47], v15
    v_exp_f32 v20, v20
    s_mov_b64 exec, s[56:57]
    ds_read_b128 v[60:63], v13 offset:12800
    s_mov_b64 exec, -1
    v_exp_f32 v21, v21
    v_exp_f32 v22, v22
    v_exp_f32 v23, v23
    v_mfma_f32_32x32x16_bf16 v[32:47], v[52:55], v[48:51], v[80:95]
    v_exp_f32 v24, v24
    ds_read_b128 v[52:55], v11 offset:16384
    v_exp_f32 v25, v25
    v_exp_f32 v26, v26
    v_exp_f32 v27, v27
    v_smfmac_f32_32x32x32_bf16 v[64:79], v[56:59], v[16:23], v15
    v_exp_f32 v28, v28
    s_mov_b64 exec, s[56:57]
    ds_read_b128 v[56:59], v13 offset:13312
    s_mov_b64 exec, -1
    v_exp_f32 v29, v29
    s_waitcnt vmcnt(9)
    ds_read_b64_tr_b16 v[208:209], v4 offset:32768
    ds_read_b64_tr_b16 v[210:211], v4 offset:33280
    v_exp_f32 v30, v30
    ds_read_b64_tr_b16 v[212:213], v5 offset:32768
    ds_read_b64_tr_b16 v[214:215], v5 offset:33280
    v_exp_f32 v31, v31
    v_mfma_f32_32x32x16_bf16 v[112:127], v[164:167], v[184:187], v[112:127]
    s_cbranch_vccz KF_PP39
    s_setprio 1
KF_PP39:
    v_exp_f32 v32, v32
    s_add_u32 s44, s44, 8192
    buffer_load_dwordx4 v[184:187], v10, s[4:7], s44 offen sc1
    v_exp_f32 v33, v33
    v_exp_f32 v34, v34
    v_exp_f32 v35, v35
    s_waitcnt lgkmcnt(0)
    v_smfmac_f32_32x32x32_bf16 v[64:79], v[60:63], v[24:31], v15
    v_exp_f32 v36, v36
    s_mov_b64 exec, s[56:57]
    ds_read_b128 v[60:63], v13 offset:13824
    s_mov_b64 exec, -1
    v_exp_f32 v37, v37
    v_exp_f32 v38, v38
    s_add_u32 m0, s69, 32768
    s_add_u32 s42, s42, 9216
    buffer_load_dwordx4 v14, s[24:27], s42 offen lds
    s_add_u32 s42, s42, 7168
    buffer_load_dwordx4 v14, s[24:27], s42 offen offset:1024 lds
    v_exp_f32 v39, v39
    v_mfma_f32_32x32x16_bf16 v[16:31], v[52:55], v[48:51], v[80:95]
    v_exp_f32 v40, v40
    ds_read_b128 v[52:55], v11 offset:17408
    v_exp_f32 v41, v41
    ds_read_b64_tr_b16 v[164:165], v5 offset:2048
    ds_read_b64_tr_b16 v[166:167], v5 offset:2560
    v_exp_f32 v42, v42
    v_exp_f32 v43, v43
    v_smfmac_f32_32x32x32_bf16 v[64:79], v[56:59], v[32:39], v15
    v_exp_f32 v44, v44
    s_mov_b64 exec, s[56:57]
    ds_read_b128 v[56:59], v13 offset:16384
    s_mov_b64 exec, -1
    v_exp_f32 v45, v45
    v_exp_f32 v46, v46
    v_exp_f32 v47, v47
    s_waitcnt vmcnt(15)
    v_mfma_f32_32x32x16_bf16 v[128:143], v[160:163], v[172:175], v[128:143]
    v_exp_f32 v16, v16
    v_exp_f32 v17, v17
    v_exp_f32 v18, v18
    v_exp_f32 v19, v19
    s_waitcnt lgkmcnt(0)
    v_smfmac_f32_32x32x32_bf16 v[64:79], v[60:63], v[40:47], v15
    v_exp_f32 v20, v20
    s_mov_b64 exec, s[56:57]
    ds_read_b128 v[60:63], v13 offset:16896
    s_mov_b64 exec, -1
    v_exp_f32 v21, v21
    s_add_u32 m0, s69, 2048
    s_add_u32 s43, s43, 123904
    buffer_load_dwordx4 v14, s[20:23], s43 offen lds
    s_add_u32 s43, s43, 7168
    buffer_load_dwordx4 v14, s[20:23], s43 offen offset:1024 lds
    v_exp_f32 v22, v22
    v_exp_f32 v23, v23
    v_mfma_f32_32x32x16_bf16 v[32:47], v[52:55], v[48:51], v[80:95]
    v_exp_f32 v24, v24
    ds_read_b128 v[52:55], v11 offset:20480
    v_exp_f32 v25, v25
    v_exp_f32 v26, v26
    v_exp_f32 v27, v27
    v_smfmac_f32_32x32x32_bf16 v[64:79], v[56:59], v[16:23], v15
    v_exp_f32 v28, v28
    s_mov_b64 exec, s[56:57]
    ds_read_b128 v[56:59], v13 offset:17408
    s_mov_b64 exec, -1
    v_exp_f32 v29, v29
    v_exp_f32 v30, v30
    v_exp_f32 v31, v31
    s_waitcnt vmcnt(16)
    v_mfma_f32_32x32x16_bf16 v[96:111], v[160:163], v[168:171], v[96:111]
    s_cbranch_vccz KF_PP41
    s_setprio 0
KF_PP41:
    v_exp_f32 v32, v32
    v_exp_f32 v33, v33
    v_exp_f32 v34, v34
    v_exp_f32 v35, v35
    s_waitcnt lgkmcnt(0)
    v_smfmac_f32_32x32x32_bf16 v[64:79], v[60:63], v[24:31], v15
    v_exp_f32 v36, v36
    s_mov_b64 exec, s[56:57]
    ds_read_b128 v[60:63], v13 offset:17920
    s_mov_b64 exec, -1
    v_exp_f32 v37, v37
    v_exp_f32 v38, v38
    v_exp_f32 v39, v39
    v_mfma_f32_32x32x16_bf16 v[16:31], v[52:55], v[48:51], v[80:95]
    v_exp_f32 v40, v40
    ds_read_b128 v[52:55], v11 offset:21504
    v_exp_f32 v41, v41
    s_waitcnt vmcnt(6)
    ds_read_b64_tr_b16 v[160:161], v4 offset:0
    ds_read_b64_tr_b16 v[162:163], v4 offset:512
    v_exp_f32 v42, v42
    v_exp_f32 v43, v43
    v_smfmac_f32_32x32x32_bf16 v[64:79], v[56:59], v[32:39], v15
    v_exp_f32 v44, v44
    s_mov_b64 exec, s[56:57]
    ds_read_b128 v[56:59], v13 offset:20480
    s_mov_b64 exec, -1
    v_exp_f32 v45, v45
    v_exp_f32 v46, v46
    v_exp_f32 v47, v47
    v_mfma_f32_32x32x16_bf16 v[144:159], v[164:167], v[172:175], v[144:159]
    s_cbranch_vccz KF_PP42
    s_setprio 1
KF_PP42:
    v_exp_f32 v16, v16
    s_add_u32 s45, s45, 8192
    buffer_load_dwordx4 v[172:175], v10, s[4:7], s45 offen sc1
    v_exp_f32 v17, v17
    v_exp_f32 v18, v18
    v_exp_f32 v19, v19
    s_waitcnt lgkmcnt(0)
    v_smfmac_f32_32x32x32_bf16 v[64:79], v[60:63], v[40:47], v15
    v_exp_f32 v20, v20
    s_mov_b64 exec, s[56:57]
    ds_read_b128 v[60:63], v13 offset:20992
    s_mov_b64 exec, -1
    v_exp_f32 v21, v21
    v_exp_f32 v22, v22
    v_exp_f32 v23, v23
    v_mfma_f32_32x32x16_bf16 v[32:47], v[52:55], v[48:51], v[80:95]
    v_exp_f32 v24, v24
    ds_read_b128 v[52:55], v11 offset:24576
    v_exp_f32 v25, v25
    v_exp_f32 v26, v26
    v_exp_f32 v27, v27
    v_smfmac_f32_32x32x32_bf16 v[64:79], v[56:59], v[16:23], v15
    v_exp_f32 v28, v28
    s_mov_b64 exec, s[56:57]
    ds_read_b128 v[56:59], v13 offset:21504
    s_mov_b64 exec, -1
    v_exp_f32 v29, v29
    s_waitcnt vmcnt(9)
    ds_read_b64_tr_b16 v[216:217], v4 offset:34816
    ds_read_b64_tr_b16 v[218:219], v4 offset:35328
    v_exp_f32 v30, v30
    ds_read_b64_tr_b16 v[220:221], v5 offset:34816
    ds_read_b64_tr_b16 v[222:223], v5 offset:35328
    v_exp_f32 v31, v31
    v_mfma_f32_32x32x16_bf16 v[112:127], v[164:167], v[168:171], v[112:127]
    v_exp_f32 v32, v32
    s_add_u32 s44, s44, 8192
    buffer_load_dwordx4 v[168:171], v10, s[4:7], s44 offen sc1
    v_exp_f32 v33, v33
    v_exp_f32 v34, v34
    v_exp_f32 v35, v35
    s_waitcnt lgkmcnt(0)
    v_smfmac_f32_32x32x32_bf16 v[64:79], v[60:63], v[24:31], v15
    v_exp_f32 v36, v36
    s_mov_b64 exec, s[56:57]
    ds_read_b128 v[60:63], v13 offset:22016
    s_mov_b64 exec, -1
    v_exp_f32 v37, v37
    v_exp_f32 v38, v38
    s_add_u32 m0, s69, 34816
    s_add_u32 s42, s42, 9216
    buffer_load_dwordx4 v14, s[24:27], s42 offen lds
    s_add_u32 s42, s42, 7168
    buffer_load_dwordx4 v14, s[24:27], s42 offen offset:1024 lds
    v_exp_f32 v39, v39
    v_mfma_f32_32x32x16_bf16 v[16:31], v[52:55], v[48:51], v[80:95]
    v_exp_f32 v40, v40
    ds_read_b128 v[52:55], v11 offset:25600
    v_exp_f32 v41, v41
    ds_read_b64_tr_b16 v[164:165], v5 offset:0
    ds_read_b64_tr_b16 v[166:167], v5 offset:512
    v_exp_f32 v42, v42
    v_exp_f32 v43, v43
    v_smfmac_f32_32x32x32_bf16 v[64:79], v[56:59], v[32:39], v15
    v_exp_f32 v44, v44
    s_mov_b64 exec, s[56:57]
    ds_read_b128 v[56:59], v13 offset:24576
    s_mov_b64 exec, -1
    v_exp_f32 v45, v45
    v_exp_f32 v46, v46
    v_exp_f32 v47, v47
    s_waitcnt vmcnt(15)
    v_mfma_f32_32x32x16_bf16 v[128:143], v[160:163], v[180:183], v[128:143]
    s_cbranch_vccz KF_PP44
    s_setprio 0
KF_PP44:
    v_exp_f32 v16, v16
    v_exp_f32 v17, v17
    v_exp_f32 v18, v18
    v_exp_f32 v19, v19
    s_waitcnt lgkmcnt(0)
    v_smfmac_f32_32x32x32_bf16 v[64:79], v[60:63], v[40:47], v15
    v_exp_f32 v20, v20
    s_mov_b64 exec, s[56:57]
    ds_read_b128 v[60:63], v13 offset:25088
    s_mov_b64 exec, -1
    v_exp_f32 v21, v21
    s_add_u32 m0, s69, 0
    s_add_u32 s43, s43, 123904
    buffer_load_dwordx4 v14, s[20:23], s43 offen lds
    s_add_u32 s43, s43, 7168
    buffer_load_dwordx4 v14, s[20:23], s43 offen offset:1024 lds
    v_exp_f32 v22, v22
    v_exp_f32 v23, v23
    v_mfma_f32_32x32x16_bf16 v[32:47], v[52:55], v[48:51], v[80:95]
    v_exp_f32 v24, v24
    ds_read_b128 v[52:55], v11 offset:28672
    v_exp_f32 v25, v25
    v_exp_f32 v26, v26
    v_exp_f32 v27, v27
    v_smfmac_f32_32x32x32_bf16 v[64:79], v[56:59], v[16:23], v15
    v_exp_f32 v28, v28
    s_mov_b64 exec, s[56:57]
    ds_read_b128 v[56:59], v13 offset:25600
    s_mov_b64 exec, -1
    v_exp_f32 v29, v29
    v_exp_f32 v30, v30
    v_exp_f32 v31, v31
    s_waitcnt vmcnt(16)
    v_mfma_f32_32x32x16_bf16 v[96:111], v[160:163], v[176:179], v[96:111]
    s_cbranch_vccz KF_PP45
    s_setprio 1
KF_PP45:
    v_exp_f32 v32, v32
    v_exp_f32 v33, v33
    v_exp_f32 v34, v34
    v_exp_f32 v35, v35
    s_waitcnt lgkmcnt(0)
    v_smfmac_f32_32x32x32_bf16 v[64:79], v[60:63], v[24:31], v15
    v_exp_f32 v36, v36
    s_mov_b64 exec, s[56:57]
    ds_read_b128 v[60:63], v13 offset:26112
    s_mov_b64 exec, -1
    v_exp_f32 v37, v37
    v_exp_f32 v38, v38
    v_exp_f32 v39, v39
    v_mfma_f32_32x32x16_bf16 v[16:31], v[52:55], v[48:51], v[80:95]
    v_exp_f32 v40, v40
    ds_read_b128 v[52:55], v11 offset:29696
    v_exp_f32 v41, v41
    s_waitcnt vmcnt(6)
    ds_read_b64_tr_b16 v[160:161], v4 offset:2048
    ds_read_b64_tr_b16 v[162:163], v4 offset:2560
    v_exp_f32 v42, v42
    v_exp_f32 v43, v43
    v_smfmac_f32_32x32x32_bf16 v[64:79], v[56:59], v[32:39], v15
    v_exp_f32 v44, v44
    s_mov_b64 exec, s[56:57]
    ds_read_b128 v[56:59], v13 offset:28672
    s_mov_b64 exec, -1
    v_exp_f32 v45, v45
    v_exp_f32 v46, v46
    v_exp_f32 v47, v47
    v_mfma_f32_32x32x16_bf16 v[144:159], v[164:167], v[180:183], v[144:159]
    v_exp_f32 v16, v16
    s_add_u32 s45, s45, 8192
    buffer_load_dwordx4 v[180:183], v10, s[4:7], s45 offen sc1
    v_exp_f32 v17, v17
    v_exp_f32 v18, v18
    v_exp_f32 v19, v19
    s_waitcnt lgkmcnt(0)
    v_smfmac_f32_32x32x32_bf16 v[64:79], v[60:63], v[40:47], v15
    v_exp_f32 v20, v20
    s_mov_b64 exec, s[56:57]
    ds_read_b128 v[60:63], v13 offset:29184
    s_mov_b64 exec, -1
    v_exp_f32 v21, v21
    v_exp_f32 v22, v22
    v_exp_f32 v23, v23
    v_mfma_f32_32x32x16_bf16 v[32:47], v[52:55], v[48:51], v[80:95]
    v_exp_f32 v24, v24
    ds_read_b128 v[52:55], v11 offset:32768
    v_exp_f32 v25, v25
    v_exp_f32 v26, v26
    v_exp_f32 v27, v27
    v_smfmac_f32_32x32x32_bf16 v[64:79], v[56:59], v[16:23], v15
    v_exp_f32 v28, v28
    s_mov_b64 exec, s[56:57]
    ds_read_b128 v[56:59], v13 offset:29696
    s_mov_b64 exec, -1
    v_exp_f32 v29, v29
    s_waitcnt vmcnt(9)
    ds_read_b64_tr_b16 v[224:225], v4 offset:32768
    ds_read_b64_tr_b16 v[226:227], v4 offset:33280
    v_exp_f32 v30, v30
    ds_read_b64_tr_b16 v[228:229], v5 offset:32768
    ds_read_b64_tr_b16 v[230:231], v5 offset:33280
    v_exp_f32 v31, v31
    v_mfma_f32_32x32x16_bf16 v[112:127], v[164:167], v[176:179], v[112:127]
    s_cbranch_vccz KF_PP47
    s_setprio 0
KF_PP47:
    v_exp_f32 v32, v32
    s_add_u32 s44, s44, 8192
    buffer_load_dwordx4 v[176:179], v10, s[4:7], s44 offen sc1
    v_exp_f32 v33, v33
    v_exp_f32 v34, v34
    v_exp_f32 v35, v35
    s_waitcnt lgkmcnt(0)
    v_smfmac_f32_32x32x32_bf16 v[64:79], v[60:63], v[24:31], v15
    v_exp_f32 v36, v36
    s_mov_b64 exec, s[56:57]
    ds_read_b128 v[60:63], v13 offset:30208
    s_mov_b64 exec, -1
    v_exp_f32 v37, v37
    v_exp_f32 v38, v38
    s_add_u32 m0, s69, 32768
    s_add_u32 s42, s42, 9216
    buffer_load_dwordx4 v14, s[24:27], s42 offen lds
    s_add_u32 s42, s42, 7168
    buffer_load_dwordx4 v14, s[24:27], s42 offen offset:1024 lds
    v_exp_f32 v39, v39
    v_mfma_f32_32x32x16_bf16 v[16:31], v[52:55], v[48:51], v[80:95]
    v_exp_f32 v40, v40
    ds_read_b128 v[52:55], v11 offset:33792
    v_exp_f32 v41, v41
    ds_read_b64_tr_b16 v[164:165], v5 offset:2048
    ds_read_b64_tr_b16 v[166:167], v5 offset:2560
    v_exp_f32 v42, v42
    v_exp_f32 v43, v43
    v_smfmac_f32_32x32x32_bf16 v[64:79], v[56:59], v[32:39], v15
    v_exp_f32 v44, v44
    s_mov_b64 exec, s[56:57]
    ds_read_b128 v[56:59], v13 offset:32768
    s_mov_b64 exec, -1
    v_exp_f32 v45, v45
    v_exp_f32 v46, v46
    v_exp_f32 v47, v47
    s_waitcnt vmcnt(15)
    v_mfma_f32_32x32x16_bf16 v[128:143], v[160:163], v[188:191], v[128:143]
    s_cbranch_vccz KF_PP48
    s_setprio 1
KF_PP48:
    v_exp_f32 v16, v16
    v_exp_f32 v17, v17
    v_exp_f32 v18, v18
    v_exp_f32 v19, v19
    s_waitcnt lgkmcnt(0)
    v_smfmac_f32_32x32x32_bf16 v[64:79], v[60:63], v[40:47], v15
    v_exp_f32 v20, v20
    s_mov_b64 exec, s[56:57]
    ds_read_b128 v[60:63], v13 offset:33280
    s_mov_b64 exec, -1
    v_exp_f32 v21, v21
    s_add_u32 m0, s69, 2048
    s_add_u32 s43, s43, 123904
    buffer_load_dwordx4 v14, s[20:23], s43 offen lds
    s_add_u32 s43, s43, 7168
    buffer_load_dwordx4 v14, s[20:23], s43 offen offset:1024 lds
    v_exp_f32 v22, v22
    v_exp_f32 v23, v23
    v_mfma_f32_32x32x16_bf16 v[32:47], v[52:55], v[48:51], v[80:95]
    v_exp_f32 v24, v24
    ds_read_b128 v[52:55], v11 offset:36864
    v_exp_f32 v25, v25
    v_exp_f32 v26, v26
    v_exp_f32 v27, v27
    v_smfmac_f32_32x32x32_bf16 v[64:79], v[56:59], v[16:23], v15
    v_exp_f32 v28, v28
    s_mov_b64 exec, s[56:57]
    ds_read_b128 v[56:59], v13 offset:33792
    s_mov_b64 exec, -1
    v_exp_f32 v29, v29
    v_exp_f32 v30, v30
    v_exp_f32 v31, v31
    s_waitcnt vmcnt(16)
    v_mfma_f32_32x32x16_bf16 v[96:111], v[160:163], v[184:187], v[96:111]
    v_exp_f32 v32, v32
    v_exp_f32 v33, v33
    v_exp_f32 v34, v34
    v_exp_f32 v35, v35
    s_waitcnt lgkmcnt(0)
    v_smfmac_f32_32x32x32_bf16 v[64:79], v[60:63], v[24:31], v15
    v_exp_f32 v36, v36
    s_mov_b64 exec, s[56:57]
    ds_read_b128 v[60:63], v13 offset:34304
    s_mov_b64 exec, -1
    v_exp_f32 v37, v37
    v_exp_f32 v38, v38
    v_exp_f32 v39, v39
    v_mfma_f32_32x32x16_bf16 v[16:31], v[52:55], v[48:51], v[80:95]
    v_exp_f32 v40, v40
    ds_read_b128 v[52:55], v11 offset:37888
    v_exp_f32 v41, v41
    s_waitcnt vmcnt(6)
    ds_read_b64_tr_b16 v[160:161], v4 offset:0
    ds_read_b64_tr_b16 v[162:163], v4 offset:512
    v_exp_f32 v42, v42
    v_exp_f32 v43, v43
    v_smfmac_f32_32x32x32_bf16 v[64:79], v[56:59], v[32:39], v15
    v_exp_f32 v44, v44
    s_mov_b64 exec, s[56:57]
    ds_read_b128 v[56:59], v13 offset:36864
    s_mov_b64 exec, -1
    v_exp_f32 v45, v45
    v_exp_f32 v46, v46
    v_exp_f32 v47, v47
    v_mfma_f32_32x32x16_bf16 v[144:159], v[164:167], v[188:191], v[144:159]
    s_cbranch_vccz KF_PP50
    s_setprio 0
KF_PP50:
    v_exp_f32 v16, v16
    s_add_u32 s45, s45, 8192
    buffer_load_dwordx4 v[188:191], v10, s[4:7], s45 offen sc1
    v_exp_f32 v17, v17
    v_exp_f32 v18, v18
    v_exp_f32 v19, v19
    s_waitcnt lgkmcnt(0)
    v_smfmac_f32_32x32x32_bf16 v[64:79], v[60:63], v[40:47], v15
    v_exp_f32 v20, v20
    s_mov_b64 exec, s[56:57]
    ds_read_b128 v[60:63], v13 offset:37376
    s_mov_b64 exec, -1
    v_exp_f32 v21, v21
    v_exp_f32 v22, v22
    v_exp_f32 v23, v23
    v_mfma_f32_32x32x16_bf16 v[32:47], v[52:55], v[48:51], v[80:95]
    v_exp_f32 v24, v24
    ds_read_b128 v[52:55], v11 offset:40960
    v_exp_f32 v25, v25
    v_exp_f32 v26, v26
    v_exp_f32 v27, v27
    v_smfmac_f32_32x32x32_bf16 v[64:79], v[56:59], v[16:23], v15
    v_exp_f32 v28, v28
    s_mov_b64 exec, s[56:57]
    ds_read_b128 v[56:59], v13 offset:37888
    s_mov_b64 exec, -1
    v_exp_f32 v29, v29
    s_waitcnt vmcnt(9)
    ds_read_b64_tr_b16 v[232:233], v4 offset:34816
    ds_read_b64_tr_b16 v[234:235], v4 offset:35328
    v_exp_f32 v30, v30
    ds_read_b64_tr_b16 v[236:237], v5 offset:34816
    ds_read_b64_tr_b16 v[238:239], v5 offset:35328
    v_exp_f32 v31, v31
    v_mfma_f32_32x32x16_bf16 v[112:127], v[164:167], v[184:187], v[112:127]
    s_cbranch_vccz KF_PP51
    s_setprio 1
KF_PP51:
    v_exp_f32 v32, v32
    s_add_u32 s44, s44, 8192
    buffer_load_dwordx4 v[184:187], v10, s[4:7], s44 offen sc1
    v_exp_f32 v33, v33
    v_exp_f32 v34, v34
    v_exp_f32 v35, v35
    s_waitcnt lgkmcnt(0)
    v_smfmac_f32_32x32x32_bf16 v[64:79], v[60:63], v[24:31], v15
    v_exp_f32 v36, v36
    s_mov_b64 exec, s[56:57]
    ds_read_b128 v[60:63], v13 offset:38400
    s_mov_b64 exec, -1
    v_exp_f32 v37, v37
    v_exp_f32 v38, v38
    s_add_u32 m0, s69, 34816
    s_add_u32 s42, s42, 9216
    buffer_load_dwordx4 v14, s[24:27], s42 offen lds
    s_add_u32 s42, s42, 7168
    buffer_load_dwordx4 v14, s[24:27], s42 offen offset:1024 lds
    v_exp_f32 v39, v39
    v_mfma_f32_32x32x16_bf16 v[16:31], v[52:55], v[48:51], v[80:95]
    v_exp_f32 v40, v40
    ds_read_b128 v[52:55], v11 offset:41984
    v_exp_f32 v41, v41
    ds_read_b64_tr_b16 v[164:165], v5 offset:0
    ds_read_b64_tr_b16 v[166:167], v5 offset:512
    v_exp_f32 v42, v42
    v_exp_f32 v43, v43
    v_smfmac_f32_32x32x32_bf16 v[64:79], v[56:59], v[32:39], v15
    v_exp_f32 v44, v44
    s_mov_b64 exec, s[56:57]
    ds_read_b128 v[56:59], v13 offset:40960
    s_mov_b64 exec, -1
    v_exp_f32 v45, v45
    v_exp_f32 v46, v46
    v_exp_f32 v47, v47
    s_waitcnt vmcnt(15)
    v_mfma_f32_32x32x16_bf16 v[128:143], v[160:163], v[172:175], v[128:143]
    v_exp_f32 v16, v16
    v_exp_f32 v17, v17
    v_exp_f32 v18, v18
    v_exp_f32 v19, v19
    s_waitcnt lgkmcnt(0)
    v_smfmac_f32_32x32x32_bf16 v[64:79], v[60:63], v[40:47], v15
    v_exp_f32 v20, v20
    s_mov_b64 exec, s[56:57]
    ds_read_b128 v[60:63], v13 offset:41472
    s_mov_b64 exec, -1
    v_exp_f32 v21, v21
    s_add_u32 m0, s69, 0
    s_add_u32 s43, s43, 123904
    buffer_load_dwordx4 v14, s[20:23], s43 offen lds
    s_add_u32 s43, s43, 7168
    buffer_load_dwordx4 v14, s[20:23], s43 offen offset:1024 lds
    v_exp_f32 v22, v22
    v_exp_f32 v23, v23
    v_mfma_f32_32x32x16_bf16 v[32:47], v[52:55], v[48:51], v[80:95]
    v_exp_f32 v24, v24
    ds_read_b128 v[52:55], v11 offset:45056
    v_exp_f32 v25, v25
    v_exp_f32 v26, v26
    v_exp_f32 v27, v27
    v_smfmac_f32_32x32x32_bf16 v[64:79], v[56:59], v[16:23], v15
    v_exp_f32 v28, v28
    s_mov_b64 exec, s[56:57]
    ds_read_b128 v[56:59], v13 offset:41984
    s_mov_b64 exec, -1
    v_exp_f32 v29, v29
    v_exp_f32 v30, v30
    v_exp_f32 v31, v31
    s_waitcnt vmcnt(16)
    v_mfma_f32_32x32x16_bf16 v[96:111], v[160:163], v[168:171], v[96:111]
    s_cbranch_vccz KF_PP53
    s_setprio 0
KF_PP53:
    v_exp_f32 v32, v32
    v_exp_f32 v33, v33
    v_exp_f32 v34, v34
    v_exp_f32 v35, v35
    s_waitcnt lgkmcnt(0)
    v_smfmac_f32_32x32x32_bf16 v[64:79], v[60:63], v[24:31], v15
    v_exp_f32 v36, v36
    s_mov_b64 exec, s[56:57]
    ds_read_b128 v[60:63], v13 offset:42496
    s_mov_b64 exec, -1
    v_exp_f32 v37, v37
    v_exp_f32 v38, v38
    v_exp_f32 v39, v39
    v_mfma_f32_32x32x16_bf16 v[16:31], v[52:55], v[48:51], v[80:95]
    v_exp_f32 v40, v40
    ds_read_b128 v[52:55], v11 offset:46080
    v_exp_f32 v41, v41
    s_waitcnt vmcnt(6)
    ds_read_b64_tr_b16 v[160:161], v4 offset:2048
    ds_read_b64_tr_b16 v[162:163], v4 offset:2560
    v_exp_f32 v42, v42
    v_exp_f32 v43, v43
    v_smfmac_f32_32x32x32_bf16 v[64:79], v[56:59], v[32:39], v15
    v_exp_f32 v44, v44
    s_mov_b64 exec, s[56:57]
    ds_read_b128 v[56:59], v13 offset:45056
    s_mov_b64 exec, -1
    v_exp_f32 v45, v45
    v_exp_f32 v46, v46
    v_exp_f32 v47, v47
    v_mfma_f32_32x32x16_bf16 v[144:159], v[164:167], v[172:175], v[144:159]
    s_cbranch_vccz KF_PP54
    s_setprio 1
KF_PP54:
    v_exp_f32 v16, v16
    s_add_u32 s45, s45, 8192
    buffer_load_dwordx4 v[172:175], v10, s[4:7], s45 offen sc1
    v_exp_f32 v17, v17
    v_exp_f32 v18, v18
    v_exp_f32 v19, v19
    s_waitcnt lgkmcnt(0)
    v_smfmac_f32_32x32x32_bf16 v[64:79], v[60:63], v[40:47], v15
    v_exp_f32 v20, v20
    s_mov_b64 exec, s[56:57]
    ds_read_b128 v[60:63], v13 offset:45568
    s_mov_b64 exec, -1
    v_exp_f32 v21, v21
    v_exp_f32 v22, v22
    v_exp_f32 v23, v23
    v_mfma_f32_32x32x16_bf16 v[32:47], v[52:55], v[48:51], v[80:95]
    v_exp_f32 v24, v24
    ds_read_b128 v[52:55], v11 offset:49152
    v_exp_f32 v25, v25
    v_exp_f32 v26, v26
    v_exp_f32 v27, v27
    v_smfmac_f32_32x32x32_bf16 v[64:79], v[56:59], v[16:23], v15
    v_exp_f32 v28, v28
    s_mov_b64 exec, s[56:57]
    ds_read_b128 v[56:59], v13 offset:46080
    s_mov_b64 exec, -1
    v_exp_f32 v29, v29
    s_waitcnt vmcnt(9)
    ds_read_b64_tr_b16 v[240:241], v4 offset:32768
    ds_read_b64_tr_b16 v[242:243], v4 offset:33280
    v_exp_f32 v30, v30
    ds_read_b64_tr_b16 v[244:245], v5 offset:32768
    ds_read_b64_tr_b16 v[246:247], v5 offset:33280
    v_exp_f32 v31, v31
    v_mfma_f32_32x32x16_bf16 v[112:127], v[164:167], v[168:171], v[112:127]
    v_exp_f32 v32, v32
    s_add_u32 s44, s44, 8192
    buffer_load_dwordx4 v[168:171], v10, s[4:7], s44 offen sc1
    v_exp_f32 v33, v33
    v_exp_f32 v34, v34
    v_exp_f32 v35, v35
    s_waitcnt lgkmcnt(0)
    v_smfmac_f32_32x32x32_bf16 v[64:79], v[60:63], v[24:31], v15
    v_exp_f32 v36, v36
    s_mov_b64 exec, s[56:57]
    ds_read_b128 v[60:63], v13 offset:46592
    s_mov_b64 exec, -1
    v_exp_f32 v37, v37
    v_exp_f32 v38, v38
    v_exp_f32 v39, v39
    v_mfma_f32_32x32x16_bf16 v[16:31], v[52:55], v[48:51], v[80:95]
    v_exp_f32 v40, v40
    ds_read_b128 v[52:55], v11 offset:50176
    v_exp_f32 v41, v41
    ds_read_b64_tr_b16 v[164:165], v5 offset:2048
    ds_read_b64_tr_b16 v[166:167], v5 offset:2560
    v_exp_f32 v42, v42
    v_exp_f32 v43, v43
    v_smfmac_f32_32x32x32_bf16 v[64:79], v[56:59], v[32:39], v15
    v_exp_f32 v44, v44
    s_mov_b64 exec, s[56:57]
    ds_read_b128 v[56:59], v13 offset:49152
    s_mov_b64 exec, -1
    v_exp_f32 v45, v45
    v_exp_f32 v46, v46
    v_exp_f32 v47, v47
    s_waitcnt vmcnt(13)
    v_mfma_f32_32x32x16_bf16 v[128:143], v[160:163], v[180:183], v[128:143]
    s_cbranch_vccz KF_PP56
    s_setprio 0
KF_PP56:
    v_exp_f32 v16, v16
    v_exp_f32 v17, v17
    v_exp_f32 v18, v18
    v_exp_f32 v19, v19
    s_waitcnt lgkmcnt(0)
    v_smfmac_f32_32x32x32_bf16 v[64:79], v[60:63], v[40:47], v15
    v_exp_f32 v20, v20
    s_mov_b64 exec, s[56:57]
    ds_read_b128 v[60:63], v13 offset:49664
    s_mov_b64 exec, -1
    v_exp_f32 v21, v21
    s_add_u32 m0, s69, 2048
    s_add_u32 s43, s43, 123904
    buffer_load_dwordx4 v14, s[20:23], s43 offen lds
    s_add_u32 s43, s43, 7168
    buffer_load_dwordx4 v14, s[20:23], s43 offen offset:1024 lds
    v_exp_f32 v22, v22
    v_exp_f32 v23, v23
    v_mfma_f32_32x32x16_bf16 v[32:47], v[52:55], v[48:51], v[80:95]
    v_exp_f32 v24, v24
    ds_read_b128 v[52:55], v11 offset:53248
    v_exp_f32 v25, v25
    v_exp_f32 v26, v26
    v_exp_f32 v27, v27
    v_smfmac_f32_32x32x32_bf16 v[64:79], v[56:59], v[16:23], v15
    v_exp_f32 v28, v28
    s_mov_b64 exec, s[56:57]
    ds_read_b128 v[56:59], v13 offset:50176
    s_mov_b64 exec, -1
    v_exp_f32 v29, v29
    v_exp_f32 v30, v30
    v_exp_f32 v31, v31
    s_waitcnt vmcnt(14)
    v_mfma_f32_32x32x16_bf16 v[96:111], v[160:163], v[176:179], v[96:111]
    s_cbranch_vccz KF_PP57
    s_setprio 1
KF_PP57:
    v_exp_f32 v32, v32
    v_exp_f32 v33, v33
    v_exp_f32 v34, v34
    v_exp_f32 v35, v35
    s_waitcnt lgkmcnt(0)
    v_smfmac_f32_32x32x32_bf16 v[64:79], v[60:63], v[24:31], v15
    v_exp_f32 v36, v36
    s_mov_b64 exec, s[56:57]
    ds_read_b128 v[60:63], v13 offset:50688
    s_mov_b64 exec, -1
    v_exp_f32 v37, v37
    v_exp_f32 v38, v38
    v_exp_f32 v39, v39
    v_mfma_f32_32x32x16_bf16 v[16:31], v[52:55], v[48:51], v[80:95]
    v_exp_f32 v40, v40
    ds_read_b128 v[52:55], v11 offset:54272
    v_exp_f32 v41, v41
    s_waitcnt vmcnt(4)
    ds_read_b64_tr_b16 v[160:161], v4 offset:0
    ds_read_b64_tr_b16 v[162:163], v4 offset:512
    v_exp_f32 v42, v42
    v_exp_f32 v43, v43
    v_smfmac_f32_32x32x32_bf16 v[64:79], v[56:59], v[32:39], v15
    v_exp_f32 v44, v44
    s_mov_b64 exec, s[56:57]
    ds_read_b128 v[56:59], v13 offset:53248
    s_mov_b64 exec, -1
    v_exp_f32 v45, v45
    v_exp_f32 v46, v46
    v_exp_f32 v47, v47
    v_mfma_f32_32x32x16_bf16 v[144:159], v[164:167], v[180:183], v[144:159]
    v_exp_f32 v16, v16
    s_add_u32 s45, s45, 8192
    s_cmp_ge_u32 s40, 6
    s_cmov_b32 s45, 1073741824
    buffer_load_dwordx4 v[180:183], v10, s[4:7], s45 offen sc1
    v_exp_f32 v17, v17
    v_exp_f32 v18, v18
    v_exp_f32 v19, v19
    s_waitcnt lgkmcnt(0)
    v_smfmac_f32_32x32x32_bf16 v[64:79], v[60:63], v[40:47], v15
    v_exp_f32 v20, v20
    s_mov_b64 exec, s[56:57]
    ds_read_b128 v[60:63], v13 offset:53760
    s_mov_b64 exec, -1
    v_exp_f32 v21, v21
    v_exp_f32 v22, v22
    v_exp_f32 v23, v23
    v_mfma_f32_32x32x16_bf16 v[32:47], v[52:55], v[48:51], v[80:95]
    v_exp_f32 v24, v24
    ds_read_b128 v[52:55], v11 offset:57344
    v_exp_f32 v25, v25
    v_exp_f32 v26, v26
    v_exp_f32 v27, v27
    v_smfmac_f32_32x32x32_bf16 v[64:79], v[56:59], v[16:23], v15
    v_exp_f32 v28, v28
    s_mov_b64 exec, s[56:57]
    ds_read_b128 v[56:59], v13 offset:54272
    s_mov_b64 exec, -1
    v_exp_f32 v29, v29
    s_waitcnt vmcnt(7)
    ds_read_b64_tr_b16 v[248:249], v4 offset:34816
    ds_read_b64_tr_b16 v[250:251], v4 offset:35328
    v_exp_f32 v30, v30
    ds_read_b64_tr_b16 v[252:253], v5 offset:34816
    ds_read_b64_tr_b16 v[254:255], v5 offset:35328
    v_exp_f32 v31, v31
    v_mfma_f32_32x32x16_bf16 v[112:127], v[164:167], v[176:179], v[112:127]
    s_cbranch_vccz KF_PP59
    s_setprio 0
KF_PP59:
    v_exp_f32 v32, v32
    s_add_u32 s44, s44, 8192
    s_cmp_ge_u32 s40, 6
    s_cmov_b32 s44, 1073741824
    buffer_load_dwordx4 v[176:179], v10, s[4:7], s44 offen sc1
    v_exp_f32 v33, v33
    v_exp_f32 v34, v34
    v_exp_f32 v35, v35
    s_waitcnt lgkmcnt(0)
    v_smfmac_f32_32x32x32_bf16 v[64:79], v[60:63], v[24:31], v15
    v_exp_f32 v36, v36
    s_mov_b64 exec, s[56:57]
    ds_read_b128 v[60:63], v13 offset:54784
    s_mov_b64 exec, -1
    v_exp_f32 v37, v37
    v_exp_f32 v38, v38
    v_exp_f32 v39, v39
    v_mfma_f32_32x32x16_bf16 v[16:31], v[52:55], v[48:51], v[80:95]
    v_exp_f32 v40, v40
    ds_read_b128 v[52:55], v11 offset:58368
    v_exp_f32 v41, v41
    ds_read_b64_tr_b16 v[164:165], v5 offset:0
    ds_read_b64_tr_b16 v[166:167], v5 offset:512
    v_exp_f32 v42, v42
    v_exp_f32 v43, v43
    v_smfmac_f32_32x32x32_bf16 v[64:79], v[56:59], v[32:39], v15
    v_exp_f32 v44, v44
    s_mov_b64 exec, s[56:57]
    ds_read_b128 v[56:59], v13 offset:57344
    s_mov_b64 exec, -1
    v_exp_f32 v45, v45
    v_exp_f32 v46, v46
    v_exp_f32 v47, v47
    s_waitcnt vmcnt(11)
    v_mfma_f32_32x32x16_bf16 v[128:143], v[160:163], v[188:191], v[128:143]
    s_cbranch_vccz KF_PP60
    s_setprio 1
KF_PP60:
    v_exp_f32 v16, v16
    v_exp_f32 v17, v17
    v_exp_f32 v18, v18
    v_exp_f32 v19, v19
    s_waitcnt lgkmcnt(0)
    v_smfmac_f32_32x32x32_bf16 v[64:79], v[60:63], v[40:47], v15
    v_exp_f32 v20, v20
    s_mov_b64 exec, s[56:57]
    ds_read_b128 v[60:63], v13 offset:57856
    s_mov_b64 exec, -1
    v_exp_f32 v21, v21
    s_add_u32 m0, s69, 0
    s_add_u32 s43, s43, 123904
    buffer_load_dwordx4 v14, s[20:23], s43 offen lds
    s_add_u32 s43, s43, 7168
    buffer_load_dwordx4 v14, s[20:23], s43 offen offset:1024 lds
    v_exp_f32 v22, v22
    v_exp_f32 v23, v23
    v_mfma_f32_32x32x16_bf16 v[32:47], v[52:55], v[48:51], v[80:95]
    v_exp_f32 v24, v24
    ds_read_b128 v[52:55], v11 offset:61440
    v_exp_f32 v25, v25
    v_exp_f32 v26, v26
    v_exp_f32 v27, v27
    v_smfmac_f32_32x32x32_bf16 v[64:79], v[56:59], v[16:23], v15
    v_exp_f32 v28, v28
    s_mov_b64 exec, s[56:57]
    ds_read_b128 v[56:59], v13 offset:58368
    s_mov_b64 exec, -1
    v_exp_f32 v29, v29
    v_exp_f32 v30, v30
    v_exp_f32 v31, v31
    s_waitcnt vmcnt(12)
    v_mfma_f32_32x32x16_bf16 v[96:111], v[160:163], v[184:187], v[96:111]
    v_exp_f32 v32, v32
    v_exp_f32 v33, v33
    v_exp_f32 v34, v34
    v_exp_f32 v35, v35
    s_waitcnt lgkmcnt(0)
    v_smfmac_f32_32x32x32_bf16 v[64:79], v[60:63], v[24:31], v15
    v_exp_f32 v36, v36
    s_mov_b64 exec, s[56:57]
    ds_read_b128 v[60:63], v13 offset:58880
    s_mov_b64 exec, -1
    v_exp_f32 v37, v37
    v_exp_f32 v38, v38
    v_exp_f32 v39, v39
    v_mfma_f32_32x32x16_bf16 v[16:31], v[52:55], v[48:51], v[80:95]
    v_exp_f32 v40, v40
    ds_read_b128 v[52:55], v11 offset:62464
    v_exp_f32 v41, v41
    s_waitcnt vmcnt(4)
    ds_read_b64_tr_b16 v[160:161], v4 offset:2048
    ds_read_b64_tr_b16 v[162:163], v4 offset:2560
    v_exp_f32 v42, v42
    v_exp_f32 v43, v43
    v_smfmac_f32_32x32x32_bf16 v[64:79], v[56:59], v[32:39], v15
    v_exp_f32 v44, v44
    s_mov_b64 exec, s[56:57]
    ds_read_b128 v[56:59], v13 offset:61440
    s_mov_b64 exec, -1
    v_exp_f32 v45, v45
    v_exp_f32 v46, v46
    v_exp_f32 v47, v47
    v_mfma_f32_32x32x16_bf16 v[144:159], v[164:167], v[188:191], v[144:159]
    s_cbranch_vccz KF_PP62
    s_setprio 0
KF_PP62:
    v_exp_f32 v16, v16
    v_exp_f32 v17, v17
    v_exp_f32 v18, v18
    v_exp_f32 v19, v19
    s_waitcnt lgkmcnt(0)
    v_smfmac_f32_32x32x32_bf16 v[64:79], v[60:63], v[40:47], v15
    v_exp_f32 v20, v20
    s_mov_b64 exec, s[56:57]
    ds_read_b128 v[60:63], v13 offset:61952
    s_mov_b64 exec, -1
    v_exp_f32 v21, v21
    v_exp_f32 v22, v22
    v_exp_f32 v23, v23
    v_mfma_f32_32x32x16_bf16 v[32:47], v[52:55], v[48:51], v[80:95]
    v_exp_f32 v24, v24
    s_nop 0
    v_exp_f32 v25, v25
    v_exp_f32 v26, v26
    v_exp_f32 v27, v27
    v_smfmac_f32_32x32x32_bf16 v[64:79], v[56:59], v[16:23], v15
    v_exp_f32 v28, v28
    s_mov_b64 exec, s[56:57]
    ds_read_b128 v[56:59], v13 offset:62464
    s_mov_b64 exec, -1
    v_exp_f32 v29, v29
    v_exp_f32 v30, v30
    v_exp_f32 v31, v31
    v_mfma_f32_32x32x16_bf16 v[112:127], v[164:167], v[184:187], v[112:127]
    s_cbranch_vccz KF_PP63
    s_setprio 1
KF_PP63:
    v_exp_f32 v32, v32
    v_exp_f32 v33, v33
    v_exp_f32 v34, v34
    v_exp_f32 v35, v35
    s_waitcnt lgkmcnt(0)
    v_smfmac_f32_32x32x32_bf16 v[64:79], v[60:63], v[24:31], v15
    v_exp_f32 v36, v36
    s_mov_b64 exec, s[56:57]
    ds_read_b128 v[60:63], v13 offset:62976
    s_mov_b64 exec, -1
    v_exp_f32 v37, v37
    v_exp_f32 v38, v38
    v_exp_f32 v39, v39
    v_exp_f32 v40, v40
    v_exp_f32 v41, v41
    ds_read_b64_tr_b16 v[164:165], v5 offset:2048
    ds_read_b64_tr_b16 v[166:167], v5 offset:2560
    v_exp_f32 v42, v42
    v_exp_f32 v43, v43
    v_smfmac_f32_32x32x32_bf16 v[64:79], v[56:59], v[32:39], v15
    v_exp_f32 v44, v44
    v_exp_f32 v45, v45
    v_exp_f32 v46, v46
    v_exp_f32 v47, v47
    s_waitcnt vmcnt(7)
    v_mfma_f32_32x32x16_bf16 v[128:143], v[160:163], v[172:175], v[128:143]
    s_waitcnt lgkmcnt(0)
    s_setprio 0
    v_smfmac_f32_32x32x32_bf16 v[64:79], v[60:63], v[40:47], v15
    s_mov_b32 s74, 0x71800000
    v_add_u32 v1, s69, v10
    v_sub_f32 v9, 1.0, v9
    s_nop 8
    v_mul_f32 v3, 0, v64
    v_fma_f32 v3, v65, 0, v3
    v_fma_f32 v3, v66, 0, v3
    v_fma_f32 v3, v67, 0, v3
    v_fma_f32 v3, v68, 0, v3
    v_fma_f32 v3, v69, 0, v3
    v_fma_f32 v3, v70, 0, v3
    v_fma_f32 v3, v71, 0, v3
    v_add_f32 v3, v3, v72
    v_cmp_ngt_f32 vcc, s74, v3
    s_cbranch_vccnz KF_FB
KF_FIN:
    v_rcp_f32 v3, v72
    s_nop 0
    v_mul_f32 v3, v3, v8
    v_mul_f32 v64, v64, v3
    v_mul_f32 v65, v65, v3
    v_mul_f32 v66, v66, v3
    v_mul_f32 v67, v67, v3
    v_mul_f32 v68, v68, v3
    v_mul_f32 v69, v69, v3
    v_mul_f32 v70, v70, v3
    v_mul_f32 v71, v71, v3
    v_cvt_pk_bf16_f32 v72, v64, v65
    v_cvt_pk_bf16_f32 v73, v66, v67
    v_cvt_pk_bf16_f32 v74, v68, v69
    v_cvt_pk_bf16_f32 v75, v70, v71
    v_min_u32 v72, -2, v72
    v_min_u32 v73, -2, v73
    v_min_u32 v74, -2, v74
    v_min_u32 v75, -2, v75
    buffer_store_dwordx4 v[72:75], v10, s[4:7], s46 offen sc1
    s_waitcnt vmcnt(1)
    ds_read_b64_tr_b16 v[48:49], v4 offset:0
    ds_read_b64_tr_b16 v[50:51], v4 offset:512
    ds_read_b64_tr_b16 v[52:53], v5 offset:0
    ds_read_b64_tr_b16 v[54:55], v5 offset:512
    s_waitcnt lgkmcnt(4)
    s_waitcnt vmcnt(7)
    v_mfma_f32_32x32x16_bf16 v[144:159], v[164:167], v[172:175], v[144:159]
    s_waitcnt vmcnt(4)
    s_waitcnt lgkmcnt(0)
    v_mfma_f32_32x32x16_bf16 v[128:143], v[48:51], v[180:183], v[128:143]
    s_waitcnt vmcnt(3)
    v_mfma_f32_32x32x16_bf16 v[144:159], v[52:55], v[180:183], v[144:159]
    s_lshl_b32 s74, s40, 13
    s_add_u32 s74, s74, 0x10000
    v_add_u32 v4, s74, v10
    v_xor_b32 v5, 16384, v4
    v_xor_b32 v6, 32768, v4
    v_xor_b32 v7, 49152, v4
    v_and_b32 v3, 31, v2
    v_lshrrev_b32 v13, 5, v2
    v_lshlrev_b32 v13, 4, v13
    v_lshl_add_u32 v13, v3, 10, v13
    s_lshl_b32 s74, s70, 16
    s_lshl_b32 s75, s71, 7
    s_add_u32 s74, s74, s75
    s_and_b32 s75, s40, 1
    s_lshl_b32 s75, s75, 15
    s_add_u32 s74, s74, s75
    s_lshr_b32 s75, s40, 1
    s_lshl_b32 s75, s75, 5
    s_add_u32 s74, s74, s75
    s_movk_i32 s75, 255
    ds_write_b128 v1, v[128:131] offset:0
    ds_write_b128 v1, v[132:135] offset:1024
    ds_write_b128 v1, v[136:139] offset:2048
    ds_write_b128 v1, v[140:143] offset:3072
    ds_write_b128 v1, v[144:147] offset:32768
    ds_write_b128 v1, v[148:151] offset:33792
    ds_write_b128 v1, v[152:155] offset:34816
    ds_write_b128 v1, v[156:159] offset:35840
    v_mfma_f32_32x32x16_bf16 v[96:111], v[160:163], v[168:171], v[96:111]
    v_mfma_f32_32x32x16_bf16 v[112:127], v[164:167], v[168:171], v[112:127]
    v_mfma_f32_32x32x16_bf16 v[96:111], v[48:51], v[176:179], v[96:111]
    v_mfma_f32_32x32x16_bf16 v[112:127], v[52:55], v[176:179], v[112:127]
    v_xor_b32 v1, 4096, v1
    s_waitcnt lgkmcnt(0)
    s_barrier
    ds_read_b128 v[128:131], v1 offset:0
    ds_read_b128 v[132:135], v1 offset:1024
    ds_read_b128 v[136:139], v1 offset:2048
    ds_read_b128 v[140:143], v1 offset:3072
    ds_read_b128 v[144:147], v1 offset:32768
    ds_read_b128 v[148:151], v1 offset:33792
    ds_read_b128 v[152:155], v1 offset:34816
    ds_read_b128 v[156:159], v1 offset:35840
    buffer_load_dwordx4 v[16:19], v10, s[4:7], s47 offen offset:0 sc1
    s_waitcnt lgkmcnt(7)
    v_add_f32 v96, v128, v96
    v_add_f32 v97, v129, v97
    v_add_f32 v98, v130, v98
    v_add_f32 v99, v131, v99
    v_mul_f32 v96, v96, v9
    v_mul_f32 v97, v97, v9
    v_mul_f32 v98, v98, v9
    v_mul_f32 v99, v99, v9
    buffer_load_dwordx4 v[20:23], v10, s[4:7], s47 offen offset:1024 sc1
    s_waitcnt lgkmcnt(6)
    v_add_f32 v100, v132, v100
    v_add_f32 v101, v133, v101
    v_add_f32 v102, v134, v102
    v_add_f32 v103, v135, v103
    v_mul_f32 v100, v100, v9
    v_mul_f32 v101, v101, v9
    v_mul_f32 v102, v102, v9
    v_mul_f32 v103, v103, v9
    buffer_load_dwordx4 v[24:27], v10, s[4:7], s47 offen offset:2048 sc1
    s_waitcnt lgkmcnt(5)
    v_add_f32 v104, v136, v104
    v_add_f32 v105, v137, v105
    v_add_f32 v106, v138, v106
    v_add_f32 v107, v139, v107
    v_mul_f32 v104, v104, v9
    v_mul_f32 v105, v105, v9
    v_mul_f32 v106, v106, v9
    v_mul_f32 v107, v107, v9
    buffer_load_dwordx4 v[28:31], v10, s[4:7], s47 offen offset:3072 sc1
    s_waitcnt lgkmcnt(4)
    v_add_f32 v108, v140, v108
    v_add_f32 v109, v141, v109
    v_add_f32 v110, v142, v110
    v_add_f32 v111, v143, v111
    v_mul_f32 v108, v108, v9
    v_mul_f32 v109, v109, v9
    v_mul_f32 v110, v110, v9
    v_mul_f32 v111, v111, v9
    buffer_load_dwordx4 v[32:35], v10, s[4:7], s48 offen offset:0 sc1
    s_waitcnt lgkmcnt(3)
    v_add_f32 v112, v144, v112
    v_add_f32 v113, v145, v113
    v_add_f32 v114, v146, v114
    v_add_f32 v115, v147, v115
    v_mul_f32 v112, v112, v9
    v_mul_f32 v113, v113, v9
    v_mul_f32 v114, v114, v9
    v_mul_f32 v115, v115, v9
    buffer_load_dwordx4 v[36:39], v10, s[4:7], s48 offen offset:1024 sc1
    s_waitcnt lgkmcnt(2)
    v_add_f32 v116, v148, v116
    v_add_f32 v117, v149, v117
    v_add_f32 v118, v150, v118
    v_add_f32 v119, v151, v119
    v_mul_f32 v116, v116, v9
    v_mul_f32 v117, v117, v9
    v_mul_f32 v118, v118, v9
    v_mul_f32 v119, v119, v9
    buffer_load_dwordx4 v[40:43], v10, s[4:7], s48 offen offset:2048 sc1
    s_waitcnt lgkmcnt(1)
    v_add_f32 v120, v152, v120
    v_add_f32 v121, v153, v121
    v_add_f32 v122, v154, v122
    v_add_f32 v123, v155, v123
    v_mul_f32 v120, v120, v9
    v_mul_f32 v121, v121, v9
    v_mul_f32 v122, v122, v9
    v_mul_f32 v123, v123, v9
    buffer_load_dwordx4 v[44:47], v10, s[4:7], s48 offen offset:3072 sc1
    s_waitcnt lgkmcnt(0)
    v_add_f32 v124, v156, v124
    v_add_f32 v125, v157, v125
    v_add_f32 v126, v158, v126
    v_add_f32 v127, v159, v127
    v_mul_f32 v124, v124, v9
    v_mul_f32 v125, v125, v9
    v_mul_f32 v126, v126, v9
    v_mul_f32 v127, v127, v9
KF_OP:
    s_bitcmp0_b32 s75, 0
    s_cbranch_scc1 KF_OS0
    s_waitcnt vmcnt(7)
    v_max3_u32 v3, v16, v17, v18
    v_max_u32 v3, v3, v19
    v_cmp_eq_u32 vcc, -1, v3
    s_cbranch_vccnz KF_OS0
    v_mfma_f32_32x32x16_bf16 v[112:127], v[196:199], v[16:19], v[112:127]
    v_mfma_f32_32x32x16_bf16 v[96:111], v[192:195], v[16:19], v[96:111]
    s_bitset0_b32 s75, 0
KF_OS0:
    s_bitcmp0_b32 s75, 1
    s_cbranch_scc1 KF_OS1
    s_waitcnt vmcnt(6)
    v_max3_u32 v3, v20, v21, v22
    v_max_u32 v3, v3, v23
    v_cmp_eq_u32 vcc, -1, v3
    s_cbranch_vccnz KF_OS1
    v_mfma_f32_32x32x16_bf16 v[112:127], v[204:207], v[20:23], v[112:127]
    v_mfma_f32_32x32x16_bf16 v[96:111], v[200:203], v[20:23], v[96:111]
    s_bitset0_b32 s75, 1
KF_OS1:
    s_bitcmp0_b32 s75, 2
    s_cbranch_scc1 KF_OS2
    s_waitcnt vmcnt(5)
    v_max3_u32 v3, v24, v25, v26
    v_max_u32 v3, v3, v27
    v_cmp_eq_u32 vcc, -1, v3
    s_cbranch_vccnz KF_OS2
    v_mfma_f32_32x32x16_bf16 v[112:127], v[212:215], v[24:27], v[112:127]
    v_mfma_f32_32x32x16_bf16 v[96:111], v[208:211], v[24:27], v[96:111]
    s_bitset0_b32 s75, 2
KF_OS2:
    s_bitcmp0_b32 s75, 3
    s_cbranch_scc1 KF_OS3
    s_waitcnt vmcnt(4)
    v_max3_u32 v3, v28, v29, v30
    v_max_u32 v3, v3, v31
    v_cmp_eq_u32 vcc, -1, v3
    s_cbranch_vccnz KF_OS3
    v_mfma_f32_32x32x16_bf16 v[112:127], v[220:223], v[28:31], v[112:127]
    v_mfma_f32_32x32x16_bf16 v[96:111], v[216:219], v[28:31], v[96:111]
    s_bitset0_b32 s75, 3
KF_OS3:
    s_bitcmp0_b32 s75, 4
    s_cbranch_scc1 KF_OS4
    s_waitcnt vmcnt(3)
    v_max3_u32 v3, v32, v33, v34
    v_max_u32 v3, v3, v35
    v_cmp_eq_u32 vcc, -1, v3
    s_cbranch_vccnz KF_OS4
    v_mfma_f32_32x32x16_bf16 v[112:127], v[228:231], v[32:35], v[112:127]
    v_mfma_f32_32x32x16_bf16 v[96:111], v[224:227], v[32:35], v[96:111]
    s_bitset0_b32 s75, 4
KF_OS4:
    s_bitcmp0_b32 s75, 5
    s_cbranch_scc1 KF_OS5
    s_waitcnt vmcnt(2)
    v_max3_u32 v3, v36, v37, v38
    v_max_u32 v3, v3, v39
    v_cmp_eq_u32 vcc, -1, v3
    s_cbranch_vccnz KF_OS5
    v_mfma_f32_32x32x16_bf16 v[112:127], v[236:239], v[36:39], v[112:127]
    v_mfma_f32_32x32x16_bf16 v[96:111], v[232:235], v[36:39], v[96:111]
    s_bitset0_b32 s75, 5
KF_OS5:
    s_bitcmp0_b32 s75, 6
    s_cbranch_scc1 KF_OS6
    s_waitcnt vmcnt(1)
    v_max3_u32 v3, v40, v41, v42
    v_max_u32 v3, v3, v43
    v_cmp_eq_u32 vcc, -1, v3
    s_cbranch_vccnz KF_OS6
    v_mfma_f32_32x32x16_bf16 v[112:127], v[244:247], v[40:43], v[112:127]
    v_mfma_f32_32x32x16_bf16 v[96:111], v[240:243], v[40:43], v[96:111]
    s_bitset0_b32 s75, 6
KF_OS6:
    s_bitcmp0_b32 s75, 7
    s_cbranch_scc1 KF_OS7
    s_waitcnt vmcnt(0)
    v_max3_u32 v3, v44, v45, v46
    v_max_u32 v3, v3, v47
    v_cmp_eq_u32 vcc, -1, v3
    s_cbranch_vccnz KF_OS7
    v_mfma_f32_32x32x16_bf16 v[112:127], v[252:255], v[44:47], v[112:127]
    v_mfma_f32_32x32x16_bf16 v[96:111], v[248:251], v[44:47], v[96:111]
    s_bitset0_b32 s75, 7
KF_OS7:
    s_cmp_lg_u32 s75, 0
    s_cbranch_scc1 KF_OR
KF_OD:
    s_nop 7
    ds_write_b128 v6, v[112:115] offset:4096
    ds_write_b128 v6, v[116:119] offset:5120
    ds_write_b128 v7, v[120:123] offset:6144
    ds_write_b128 v7, v[124:127] offset:7168
    ds_write_b128 v5, v[104:107] offset:2048
    ds_write_b128 v5, v[108:111] offset:3072
    s_waitcnt lgkmcnt(0)
    s_barrier
    ds_read_b128 v[20:23], v4 offset:2048
    ds_read_b128 v[24:27], v4 offset:4096
    ds_read_b128 v[28:31], v4 offset:6144
    ds_read_b128 v[36:39], v4 offset:3072
    ds_read_b128 v[40:43], v4 offset:5120
    ds_read_b128 v[44:47], v4 offset:7168
    s_waitcnt lgkmcnt(5)
    v_add_f32 v16, v96, v20
    v_add_f32 v17, v97, v21
    v_add_f32 v18, v98, v22
    v_add_f32 v19, v99, v23
    s_waitcnt lgkmcnt(3)
    v_add_f32 v24, v24, v28
    v_add_f32 v25, v25, v29
    v_add_f32 v26, v26, v30
    v_add_f32 v27, v27, v31
    v_add_f32 v16, v16, v24
    v_add_f32 v17, v17, v25
    v_add_f32 v18, v18, v26
    v_add_f32 v19, v19, v27
    v_cvt_pk_bf16_f32 v48, v16, v17
    v_cvt_pk_bf16_f32 v49, v18, v19
    s_waitcnt lgkmcnt(2)
    v_add_f32 v32, v100, v36
    v_add_f32 v33, v101, v37
    v_add_f32 v34, v102, v38
    v_add_f32 v35, v103, v39
    s_waitcnt lgkmcnt(0)
    v_add_f32 v40, v40, v44
    v_add_f32 v41, v41, v45
    v_add_f32 v42, v42, v46
    v_add_f32 v43, v43, v47
    v_add_f32 v32, v32, v40
    v_add_f32 v33, v33, v41
    v_add_f32 v34, v34, v42
    v_add_f32 v35, v35, v43
    v_cvt_pk_bf16_f32 v50, v32, v33
    v_cvt_pk_bf16_f32 v51, v34, v35
    buffer_store_dwordx4 v[48:51], v13, s[28:31], s74 offen nt
KF_END:
    s_endpgm
KF_OR:
    s_sub_u32 s61, s61, 1
    s_cbranch_scc1 KF_OD
    s_bitcmp0_b32 s75, 0
    s_cbranch_scc1 KF_OR0
    buffer_load_dwordx4 v[16:19], v10, s[4:7], s47 offen offset:0 sc1
KF_OR0:
    s_bitcmp0_b32 s75, 1
    s_cbranch_scc1 KF_OR1
    buffer_load_dwordx4 v[20:23], v10, s[4:7], s47 offen offset:1024 sc1
KF_OR1:
    s_bitcmp0_b32 s75, 2
    s_cbranch_scc1 KF_OR2
    buffer_load_dwordx4 v[24:27], v10, s[4:7], s47 offen offset:2048 sc1
KF_OR2:
    s_bitcmp0_b32 s75, 3
    s_cbranch_scc1 KF_OR3
    buffer_load_dwordx4 v[28:31], v10, s[4:7], s47 offen offset:3072 sc1
KF_OR3:
    s_bitcmp0_b32 s75, 4
    s_cbranch_scc1 KF_OR4
    buffer_load_dwordx4 v[32:35], v10, s[4:7], s48 offen offset:0 sc1
KF_OR4:
    s_bitcmp0_b32 s75, 5
    s_cbranch_scc1 KF_OR5
    buffer_load_dwordx4 v[36:39], v10, s[4:7], s48 offen offset:1024 sc1
KF_OR5:
    s_bitcmp0_b32 s75, 6
    s_cbranch_scc1 KF_OR6
    buffer_load_dwordx4 v[40:43], v10, s[4:7], s48 offen offset:2048 sc1
KF_OR6:
    s_bitcmp0_b32 s75, 7
    s_cbranch_scc1 KF_OR7
    buffer_load_dwordx4 v[44:47], v10, s[4:7], s48 offen offset:3072 sc1
KF_OR7:
    s_waitcnt vmcnt(0)
    s_branch KF_OP
S0B_SP:
    s_sub_u32 s61, s61, 1
    s_cbranch_scc1 S0B_GIVE
    buffer_load_dword v14, v15, s[32:35], s69 offen sc1
    s_waitcnt vmcnt(0)
    v_cmp_eq_u32 vcc, s40, v14
    s_cmp_lg_u64 vcc, 0
    s_cbranch_scc1 S0B_SP
    s_branch S0B_OK
S0B_GIVE:
    s_mov_b32 s61, 0
    s_branch S0B_OK
KF_NB:
    s_waitcnt vmcnt(1)
    v_cmp_eq_u32 vcc, -1, v128
    s_cmp_lg_u64 vcc, 0
    s_cbranch_scc1 KF_B1B
    buffer_load_dwordx4 v[48:51], v10, s[4:7], s66 offen sc1
    s_add_u32 m0, s69, 32768
    s_lshl_b32 s3, s71, 13
    s_add_u32 s3, s3, s41
    s_and_b32 s3, s3, 0xffff
    s_add_u32 s65, s64, s3
    buffer_load_dwordx4 v10, s[4:7], s65 offen sc1 lds
    buffer_load_dwordx4 v10, s[4:7], s65 offen offset:1024 sc1 lds
    s_add_u32 m0, s69, 34816
    s_add_u32 s65, s65, 0x200000
    buffer_load_dwordx4 v10, s[4:7], s65 offen sc1 lds
    buffer_load_dwordx4 v10, s[4:7], s65 offen offset:1024 sc1 lds
    s_add_u32 m0, s69, 65536
    s_add_u32 s3, s3, 16384
    s_and_b32 s3, s3, 0xffff
    s_add_u32 s65, s64, s3
    buffer_load_dwordx4 v10, s[4:7], s65 offen sc1 lds
    buffer_load_dwordx4 v10, s[4:7], s65 offen offset:1024 sc1 lds
    s_add_u32 m0, s69, 67584
    s_add_u32 s65, s65, 0x200000
    buffer_load_dwordx4 v10, s[4:7], s65 offen sc1 lds
    buffer_load_dwordx4 v10, s[4:7], s65 offen offset:1024 sc1 lds
    s_mov_b32 s62, 1
    s_branch KF_B1B
S0A_SP:
    s_sub_u32 s61, s61, 1
    s_cbranch_scc1 S0A_GIVE
    buffer_load_dword v14, v15, s[32:35], s69 offen sc1
    s_waitcnt vmcnt(0)
    v_cmp_eq_u32 vcc, s40, v14
    s_cmp_lg_u64 vcc, 0
    s_cbranch_scc1 S0A_SP
    s_branch S0A_OK
S0A_GIVE:
    s_mov_b32 s61, 0
    s_branch S0A_OK
KF_NA:
    s_waitcnt vmcnt(1)
    v_cmp_eq_u32 vcc, -1, v128
    s_cmp_lg_u64 vcc, 0
    s_cbranch_scc1 KF_B1A
    buffer_load_dwordx4 v[48:51], v10, s[4:7], s66 offen sc1
    s_add_u32 m0, s69, 32768
    s_lshl_b32 s3, s71, 13
    s_add_u32 s3, s3, s41
    s_and_b32 s3, s3, 0xffff
    s_add_u32 s65, s64, s3
    buffer_load_dwordx4 v10, s[4:7], s65 offen sc1 lds
    buffer_load_dwordx4 v10, s[4:7], s65 offen offset:1024 sc1 lds
    s_add_u32 m0, s69, 34816
    s_add_u32 s65, s65, 0x200000
    buffer_load_dwordx4 v10, s[4:7], s65 offen sc1 lds
    buffer_load_dwordx4 v10, s[4:7], s65 offen offset:1024 sc1 lds
    s_add_u32 m0, s69, 65536
    s_add_u32 s3, s3, 16384
    s_and_b32 s3, s3, 0xffff
    s_add_u32 s65, s64, s3
    buffer_load_dwordx4 v10, s[4:7], s65 offen sc1 lds
    buffer_load_dwordx4 v10, s[4:7], s65 offen offset:1024 sc1 lds
    s_add_u32 m0, s69, 67584
    s_add_u32 s65, s65, 0x200000
    buffer_load_dwordx4 v10, s[4:7], s65 offen sc1 lds
    buffer_load_dwordx4 v10, s[4:7], s65 offen offset:1024 sc1 lds
    s_mov_b32 s62, 1
    s_branch KF_B1A
S0C_SP:
    s_sub_u32 s61, s61, 1
    s_cbranch_scc1 S0C_GIVE
    buffer_load_dword v14, v15, s[32:35], s69 offen sc1
    s_waitcnt vmcnt(0)
    v_cmp_eq_u32 vcc, s40, v14
    s_cmp_lg_u64 vcc, 0
    s_cbranch_scc1 S0C_SP
    s_branch S0C_OK
S0C_GIVE:
    s_mov_b32 s61, 0
    s_branch S0C_OK
KF_NC:
    s_waitcnt vmcnt(1)
    v_cmp_eq_u32 vcc, -1, v128
    s_cmp_lg_u64 vcc, 0
    s_cbranch_scc1 KF_B1C
    buffer_load_dwordx4 v[48:51], v10, s[4:7], s66 offen sc1
    s_add_u32 m0, s69, 32768
    s_lshl_b32 s3, s71, 13
    s_add_u32 s3, s3, s41
    s_and_b32 s3, s3, 0xffff
    s_add_u32 s65, s64, s3
    buffer_load_dwordx4 v10, s[4:7], s65 offen sc1 lds
    buffer_load_dwordx4 v10, s[4:7], s65 offen offset:1024 sc1 lds
    s_add_u32 m0, s69, 34816
    s_add_u32 s65, s65, 0x200000
    buffer_load_dwordx4 v10, s[4:7], s65 offen sc1 lds
    buffer_load_dwordx4 v10, s[4:7], s65 offen offset:1024 sc1 lds
    s_add_u32 m0, s69, 65536
    s_add_u32 s3, s3, 16384
    s_and_b32 s3, s3, 0xffff
    s_add_u32 s65, s64, s3
    buffer_load_dwordx4 v10, s[4:7], s65 offen sc1 lds
    buffer_load_dwordx4 v10, s[4:7], s65 offen offset:1024 sc1 lds
    s_add_u32 m0, s69, 67584
    s_add_u32 s65, s65, 0x200000
    buffer_load_dwordx4 v10, s[4:7], s65 offen sc1 lds
    buffer_load_dwordx4 v10, s[4:7], s65 offen offset:1024 sc1 lds
    s_mov_b32 s62, 1
    s_branch KF_B1C
GC_SP:
    s_sub_u32 s61, s61, 1
    s_cbranch_scc1 GC_GIVE
    buffer_load_dword v8, v1, s[4:7], s51 offen sc1
    buffer_load_dword v9, v1, s[4:7], s52 offen sc1
    buffer_load_dword v3, v1, s[4:7], s53 offen sc1
    s_waitcnt vmcnt(0)
    v_max3_u32 v6, v8, v9, v3
    v_cmp_eq_u32 s[62:63], -1, v6
    s_cmp_lg_u64 s[62:63], 0
    s_cbranch_scc1 GC_SP
    s_branch GC_OK
GC_GIVE:
    s_mov_b32 s61, 0
    s_branch GC_OK
KF_FB:
    v_mov_b32 v3, 0xff800000
    s_mov_b32 s65, s64
    s_movk_i32 s75, 64
KF_FB1:
    buffer_load_dwordx4 v[52:55], v10, s[4:7], s65 offen sc1
    s_waitcnt vmcnt(0)
    v_mfma_f32_32x32x16_bf16 v[16:31], v[52:55], v[48:51], 0
    s_nop 11
    v_max3_f32 v3, v16, v17, v3
    v_max3_f32 v3, v3, v18, v19
    v_max3_f32 v3, v3, v20, v21
    v_max3_f32 v3, v3, v22, v23
    v_max3_f32 v3, v3, v24, v25
    v_max3_f32 v3, v3, v26, v27
    v_max3_f32 v3, v3, v28, v29
    v_max3_f32 v3, v3, v30, v31
    s_add_u32 s65, s65, 1024
    s_sub_u32 s75, s75, 1
    s_cmp_lg_u32 s75, 0
    s_cbranch_scc1 KF_FB1
    v_mov_b32 v6, v3
    s_nop 1
    v_permlane32_swap_b32 v3, v6
    s_nop 1
    v_max_f32 v3, v3, v6
    v_sub_f32 v80, 0, v3
    v_sub_f32 v81, 0, v3
    v_sub_f32 v82, 0, v3
    v_sub_f32 v83, 0, v3
    v_sub_f32 v84, 0, v3
    v_sub_f32 v85, 0, v3
    v_sub_f32 v86, 0, v3
    v_sub_f32 v87, 0, v3
    v_sub_f32 v88, 0, v3
    v_sub_f32 v89, 0, v3
    v_sub_f32 v90, 0, v3
    v_sub_f32 v91, 0, v3
    v_sub_f32 v92, 0, v3
    v_sub_f32 v93, 0, v3
    v_sub_f32 v94, 0, v3
    v_sub_f32 v95, 0, v3
    v_mov_b32 v64, 0
    v_mov_b32 v65, 0
    v_mov_b32 v66, 0
    v_mov_b32 v67, 0
    v_mov_b32 v68, 0
    v_mov_b32 v69, 0
    v_mov_b32 v70, 0
    v_mov_b32 v71, 0
    v_mov_b32 v72, 0
    v_mov_b32 v73, 0
    v_mov_b32 v74, 0
    v_mov_b32 v75, 0
    v_mov_b32 v76, 0
    v_mov_b32 v77, 0
    v_mov_b32 v78, 0
    v_mov_b32 v79, 0
    v_add_u32 v6, 2062336, v12
    s_mov_b32 s65, s64
    s_movk_i32 s75, 64
KF_FB2:
    buffer_load_dwordx4 v[52:55], v10, s[4:7], s65 offen sc1
    s_mov_b64 exec, s[56:57]
    buffer_load_dwordx4 v[56:59], v6, s[4:7], s65 offen offset:0 sc1
    buffer_load_dwordx4 v[60:63], v6, s[4:7], s65 offen offset:512 sc1
    s_mov_b64 exec, -1
    s_waitcnt vmcnt(0)
    v_mfma_f32_32x32x16_bf16 v[16:31], v[52:55], v[48:51], v[80:95]
    s_nop 11
    v_exp_f32 v16, v16
    v_exp_f32 v17, v17
    v_exp_f32 v18, v18
    v_exp_f32 v19, v19
    v_exp_f32 v20, v20
    v_exp_f32 v21, v21
    v_exp_f32 v22, v22
    v_exp_f32 v23, v23
    v_exp_f32 v24, v24
    v_exp_f32 v25, v25
    v_exp_f32 v26, v26
    v_exp_f32 v27, v27
    v_exp_f32 v28, v28
    v_exp_f32 v29, v29
    v_exp_f32 v30, v30
    v_exp_f32 v31, v31
    s_nop 1
    v_smfmac_f32_32x32x32_bf16 v[64:79], v[56:59], v[16:23], v15
    v_smfmac_f32_32x32x32_bf16 v[64:79], v[60:63], v[24:31], v15
    s_add_u32 s65, s65, 1024
    s_sub_u32 s75, s75, 1
    s_cmp_lg_u32 s75, 0
    s_cbranch_scc1 KF_FB2
    s_nop 11
    s_branch KF_FIN
KF_P1V:
    s_waitcnt vmcnt(8)
    s_barrier
    ds_read_b128 v[128:131], v16 offset:16384
    ds_read_b64_tr_b16 v[32:33], v20 offset:0
    ds_read_b64_tr_b16 v[34:35], v20 offset:256
    ds_read_b64_tr_b16 v[36:37], v21 offset:0
    ds_read_b64_tr_b16 v[38:39], v21 offset:256
    ds_read_b128 v[132:135], v17 offset:16384
    ds_read_b64_tr_b16 v[40:41], v20 offset:2048
    ds_read_b64_tr_b16 v[42:43], v20 offset:2304
    ds_read_b64_tr_b16 v[44:45], v21 offset:2048
    ds_read_b64_tr_b16 v[46:47], v21 offset:2304
    s_waitcnt lgkmcnt(7)
    v_mfma_f32_32x32x16_bf16 v[64:79], v[128:131], v[32:35], 0
    s_add_u32 m0, s41, 114688
    s_add_u32 s3, s3, 128
    s_and_b32 s3, s3, 1023
    ds_read_b128 v[136:139], v18 offset:16384
    ds_read_b64_tr_b16 v[32:33], v20 offset:4096
    ds_read_b64_tr_b16 v[34:35], v20 offset:4352
    buffer_load_dwordx4 v22, s[8:11], s3 offen lds
    s_waitcnt lgkmcnt(8)
    v_mfma_f32_32x32x16_bf16 v[80:95], v[128:131], v[36:39], 0
    s_add_u32 m0, s41, 115712
    ds_read_b64_tr_b16 v[36:37], v21 offset:4096
    ds_read_b64_tr_b16 v[38:39], v21 offset:4352
    buffer_load_dwordx4 v23, s[8:11], s3 offen lds
    s_waitcnt lgkmcnt(7)
    v_mfma_f32_32x32x16_bf16 v[64:79], v[132:135], v[40:43], v[64:79]
    s_add_u32 m0, s41, 98304
    s_mul_i32 s44, s3, s43
    ds_read_b128 v[140:143], v19 offset:16384
    ds_read_b64_tr_b16 v[40:41], v20 offset:6144
    ds_read_b64_tr_b16 v[42:43], v20 offset:6400
    buffer_load_dwordx4 v24, s[12:15], s44 offen offset:0 lds
    s_waitcnt lgkmcnt(8)
    v_mfma_f32_32x32x16_bf16 v[80:95], v[132:135], v[44:47], v[80:95]
    s_add_u32 m0, s41, 99264
    ds_read_b64_tr_b16 v[44:45], v21 offset:6144
    ds_read_b64_tr_b16 v[46:47], v21 offset:6400
    buffer_load_dwordx4 v24, s[12:15], s44 offen offset:64 lds
    s_waitcnt lgkmcnt(7)
    v_mfma_f32_32x32x16_bf16 v[64:79], v[136:139], v[32:35], v[64:79]
    s_waitcnt vmcnt(8)
    s_barrier
    s_add_u32 m0, s41, 147456
    s_add_u32 s3, s3, 128
    s_and_b32 s3, s3, 1023
    ds_read_b128 v[144:147], v16 offset:49152
    ds_read_b64_tr_b16 v[32:33], v20 offset:32768
    ds_read_b64_tr_b16 v[34:35], v20 offset:33024
    buffer_load_dwordx4 v22, s[8:11], s3 offen lds
    s_waitcnt lgkmcnt(8)
    v_mfma_f32_32x32x16_bf16 v[80:95], v[136:139], v[36:39], v[80:95]
    ds_read_b64_tr_b16 v[36:37], v21 offset:32768
    ds_read_b64_tr_b16 v[38:39], v21 offset:33024
    s_waitcnt lgkmcnt(7)
    v_mfma_f32_32x32x16_bf16 v[64:79], v[140:143], v[40:43], v[64:79]
    s_add_u32 m0, s41, 148480
    ds_read_b128 v[148:151], v17 offset:49152
    ds_read_b64_tr_b16 v[40:41], v20 offset:34816
    ds_read_b64_tr_b16 v[42:43], v20 offset:35072
    buffer_load_dwordx4 v23, s[8:11], s3 offen lds
    s_waitcnt lgkmcnt(8)
    v_mfma_f32_32x32x16_bf16 v[80:95], v[140:143], v[44:47], v[80:95]
    ds_read_b64_tr_b16 v[44:45], v21 offset:34816
    ds_read_b64_tr_b16 v[46:47], v21 offset:35072
    s_waitcnt lgkmcnt(7)
    v_mfma_f32_32x32x16_bf16 v[64:79], v[144:147], v[32:35], v[64:79]
    s_add_u32 m0, s41, 131072
    s_mul_i32 s44, s3, s43
    ds_read_b128 v[152:155], v18 offset:49152
    ds_read_b64_tr_b16 v[32:33], v20 offset:36864
    ds_read_b64_tr_b16 v[34:35], v20 offset:37120
    buffer_load_dwordx4 v24, s[12:15], s44 offen offset:0 lds
    s_waitcnt lgkmcnt(8)
    v_mfma_f32_32x32x16_bf16 v[80:95], v[144:147], v[36:39], v[80:95]
    ds_read_b64_tr_b16 v[36:37], v21 offset:36864
    ds_read_b64_tr_b16 v[38:39], v21 offset:37120
    buffer_store_dwordx4 v[104:107], v10, s[4:7], s45 offen sc1
    s_waitcnt lgkmcnt(7)
    v_mfma_f32_32x32x16_bf16 v[64:79], v[148:151], v[40:43], v[64:79]
    s_add_u32 m0, s41, 132032
    ds_read_b128 v[156:159], v19 offset:49152
    ds_read_b64_tr_b16 v[40:41], v20 offset:38912
    ds_read_b64_tr_b16 v[42:43], v20 offset:39168
    buffer_load_dwordx4 v24, s[12:15], s44 offen offset:64 lds
    s_waitcnt lgkmcnt(8)
    v_mfma_f32_32x32x16_bf16 v[80:95], v[148:151], v[44:47], v[80:95]
    ds_read_b64_tr_b16 v[44:45], v21 offset:38912
    ds_read_b64_tr_b16 v[46:47], v21 offset:39168
    buffer_store_dwordx4 v[104:107], v10, s[4:7], s45 offen offset:1024 sc1
    s_waitcnt lgkmcnt(7)
    v_mfma_f32_32x32x16_bf16 v[64:79], v[152:155], v[32:35], v[64:79]
    s_waitcnt vmcnt(10)
    s_barrier
    s_add_u32 m0, s41, 16384
    s_add_u32 s3, s3, 128
    s_and_b32 s3, s3, 1023
    v_add_u32 v16, 65536, v16
    ds_read_b128 v[160:163], v16 offset:16384
    v_add_u32 v20, 65536, v20
    ds_read_b64_tr_b16 v[32:33], v20 offset:0
    ds_read_b64_tr_b16 v[34:35], v20 offset:256
    buffer_load_dwordx4 v22, s[8:11], s3 offen lds
    s_waitcnt lgkmcnt(8)
    v_mfma_f32_32x32x16_bf16 v[80:95], v[152:155], v[36:39], v[80:95]
    v_add_u32 v21, 65536, v21
    ds_read_b64_tr_b16 v[36:37], v21 offset:0
    ds_read_b64_tr_b16 v[38:39], v21 offset:256
    s_waitcnt lgkmcnt(7)
    v_mfma_f32_32x32x16_bf16 v[64:79], v[156:159], v[40:43], v[64:79]
    s_add_u32 m0, s41, 17408
    v_add_u32 v17, 65536, v17
    ds_read_b128 v[164:167], v17 offset:16384
    ds_read_b64_tr_b16 v[40:41], v20 offset:2048
    ds_read_b64_tr_b16 v[42:43], v20 offset:2304
    buffer_load_dwordx4 v23, s[8:11], s3 offen lds
    s_waitcnt lgkmcnt(8)
    v_mfma_f32_32x32x16_bf16 v[80:95], v[156:159], v[44:47], v[80:95]
    ds_read_b64_tr_b16 v[44:45], v21 offset:2048
    ds_read_b64_tr_b16 v[46:47], v21 offset:2304
    buffer_load_dwordx4 v[96:99], v108, s[8:11], 0 offen
    s_waitcnt lgkmcnt(7)
    v_mfma_f32_32x32x16_bf16 v[64:79], v[160:163], v[32:35], v[64:79]
    s_add_u32 m0, s41, 0
    s_mul_i32 s44, s3, s43
    v_add_u32 v18, 65536, v18
    ds_read_b128 v[168:171], v18 offset:16384
    ds_read_b64_tr_b16 v[32:33], v20 offset:4096
    ds_read_b64_tr_b16 v[34:35], v20 offset:4352
    buffer_load_dwordx4 v24, s[12:15], s44 offen offset:0 lds
    s_waitcnt lgkmcnt(8)
    v_mfma_f32_32x32x16_bf16 v[80:95], v[160:163], v[36:39], v[80:95]
    ds_read_b64_tr_b16 v[36:37], v21 offset:4096
    ds_read_b64_tr_b16 v[38:39], v21 offset:4352
    buffer_load_dwordx4 v[100:103], v10, s[36:39], 0 offen
    s_waitcnt lgkmcnt(7)
    v_mfma_f32_32x32x16_bf16 v[64:79], v[164:167], v[40:43], v[64:79]
    s_add_u32 m0, s41, 960
    v_add_u32 v19, 65536, v19
    ds_read_b128 v[172:175], v19 offset:16384
    ds_read_b64_tr_b16 v[40:41], v20 offset:6144
    ds_read_b64_tr_b16 v[42:43], v20 offset:6400
    buffer_load_dwordx4 v24, s[12:15], s44 offen offset:64 lds
    s_waitcnt lgkmcnt(8)
    v_mfma_f32_32x32x16_bf16 v[80:95], v[164:167], v[44:47], v[80:95]
    ds_read_b64_tr_b16 v[44:45], v21 offset:6144
    ds_read_b64_tr_b16 v[46:47], v21 offset:6400
    s_mov_b32 s74, 12582912
    buffer_store_dwordx4 v[104:107], v108, s[4:7], s74 offen sc1
    s_waitcnt lgkmcnt(7)
    v_mfma_f32_32x32x16_bf16 v[64:79], v[168:171], v[32:35], v[64:79]
    s_waitcnt vmcnt(13)
    s_barrier
    s_add_u32 m0, s41, 49152
    s_add_u32 s3, s3, 128
    s_and_b32 s3, s3, 1023
    ds_read_b128 v[176:179], v16 offset:49152
    ds_read_b64_tr_b16 v[32:33], v20 offset:32768
    ds_read_b64_tr_b16 v[34:35], v20 offset:33024
    buffer_load_dwordx4 v22, s[8:11], s3 offen lds
    s_waitcnt lgkmcnt(8)
    v_mfma_f32_32x32x16_bf16 v[80:95], v[168:171], v[36:39], v[80:95]
    ds_read_b64_tr_b16 v[36:37], v21 offset:32768
    ds_read_b64_tr_b16 v[38:39], v21 offset:33024
    s_waitcnt lgkmcnt(7)
    v_mfma_f32_32x32x16_bf16 v[64:79], v[172:175], v[40:43], v[64:79]
    s_add_u32 m0, s41, 50176
    ds_read_b128 v[180:183], v17 offset:49152
    ds_read_b64_tr_b16 v[40:41], v20 offset:34816
    ds_read_b64_tr_b16 v[42:43], v20 offset:35072
    buffer_load_dwordx4 v23, s[8:11], s3 offen lds
    s_waitcnt lgkmcnt(8)
    v_mfma_f32_32x32x16_bf16 v[80:95], v[172:175], v[44:47], v[80:95]
    ds_read_b64_tr_b16 v[44:45], v21 offset:34816
    ds_read_b64_tr_b16 v[46:47], v21 offset:35072
    s_waitcnt lgkmcnt(7)
    v_mfma_f32_32x32x16_bf16 v[64:79], v[176:179], v[32:35], v[64:79]
    s_add_u32 m0, s41, 32768
    s_mul_i32 s44, s3, s43
    ds_read_b128 v[184:187], v18 offset:49152
    ds_read_b64_tr_b16 v[32:33], v20 offset:36864
    ds_read_b64_tr_b16 v[34:35], v20 offset:37120
    buffer_load_dwordx4 v24, s[12:15], s44 offen offset:0 lds
    s_waitcnt lgkmcnt(8)
    v_mfma_f32_32x32x16_bf16 v[80:95], v[176:179], v[36:39], v[80:95]
    ds_read_b64_tr_b16 v[36:37], v21 offset:36864
    ds_read_b64_tr_b16 v[38:39], v21 offset:37120
    s_waitcnt lgkmcnt(7)
    v_mfma_f32_32x32x16_bf16 v[64:79], v[180:183], v[40:43], v[64:79]
    s_add_u32 m0, s41, 33728
    ds_read_b128 v[188:191], v19 offset:49152
    ds_read_b64_tr_b16 v[40:41], v20 offset:38912
    ds_read_b64_tr_b16 v[42:43], v20 offset:39168
    buffer_load_dwordx4 v24, s[12:15], s44 offen offset:64 lds
    s_waitcnt lgkmcnt(8)
    v_mfma_f32_32x32x16_bf16 v[80:95], v[180:183], v[44:47], v[80:95]
    ds_read_b64_tr_b16 v[44:45], v21 offset:38912
    ds_read_b64_tr_b16 v[46:47], v21 offset:39168
    s_waitcnt lgkmcnt(7)
    v_mfma_f32_32x32x16_bf16 v[64:79], v[184:187], v[32:35], v[64:79]
    s_waitcnt vmcnt(12)
    s_barrier
    s_add_u32 m0, s41, 81920
    s_add_u32 s3, s3, 128
    s_and_b32 s3, s3, 1023
    v_add_u32 v16, 65536, v16
    ds_read_b128 v[192:195], v16 offset:16384
    v_add_u32 v20, 65536, v20
    ds_read_b64_tr_b16 v[32:33], v20 offset:0
    ds_read_b64_tr_b16 v[34:35], v20 offset:256
    buffer_load_dwordx4 v22, s[8:11], s3 offen lds
    s_waitcnt lgkmcnt(8)
    v_mfma_f32_32x32x16_bf16 v[80:95], v[184:187], v[36:39], v[80:95]
    v_add_u32 v21, 65536, v21
    ds_read_b64_tr_b16 v[36:37], v21 offset:0
    ds_read_b64_tr_b16 v[38:39], v21 offset:256
    s_waitcnt lgkmcnt(7)
    v_mfma_f32_32x32x16_bf16 v[64:79], v[188:191], v[40:43], v[64:79]
    s_add_u32 m0, s41, 82944
    v_add_u32 v17, 65536, v17
    ds_read_b128 v[196:199], v17 offset:16384
    ds_read_b64_tr_b16 v[40:41], v20 offset:2048
    ds_read_b64_tr_b16 v[42:43], v20 offset:2304
    buffer_load_dwordx4 v23, s[8:11], s3 offen lds
    s_waitcnt lgkmcnt(8)
    v_mfma_f32_32x32x16_bf16 v[80:95], v[188:191], v[44:47], v[80:95]
    ds_read_b64_tr_b16 v[44:45], v21 offset:2048
    ds_read_b64_tr_b16 v[46:47], v21 offset:2304
    s_waitcnt lgkmcnt(7)
    v_mfma_f32_32x32x16_bf16 v[64:79], v[192:195], v[32:35], v[64:79]
    s_add_u32 m0, s41, 65536
    s_mul_i32 s44, s3, s43
    v_add_u32 v18, 65536, v18
    ds_read_b128 v[200:203], v18 offset:16384
    ds_read_b64_tr_b16 v[32:33], v20 offset:4096
    ds_read_b64_tr_b16 v[34:35], v20 offset:4352
    buffer_load_dwordx4 v24, s[12:15], s44 offen offset:0 lds
    s_waitcnt lgkmcnt(8)
    v_mfma_f32_32x32x16_bf16 v[80:95], v[192:195], v[36:39], v[80:95]
    ds_read_b64_tr_b16 v[36:37], v21 offset:4096
    ds_read_b64_tr_b16 v[38:39], v21 offset:4352
    s_waitcnt lgkmcnt(7)
    v_mfma_f32_32x32x16_bf16 v[64:79], v[196:199], v[40:43], v[64:79]
    s_add_u32 m0, s41, 66496
    v_add_u32 v19, 65536, v19
    ds_read_b128 v[204:207], v19 offset:16384
    ds_read_b64_tr_b16 v[40:41], v20 offset:6144
    ds_read_b64_tr_b16 v[42:43], v20 offset:6400
    buffer_load_dwordx4 v24, s[12:15], s44 offen offset:64 lds
    s_waitcnt lgkmcnt(8)
    v_mfma_f32_32x32x16_bf16 v[80:95], v[196:199], v[44:47], v[80:95]
    ds_read_b64_tr_b16 v[44:45], v21 offset:6144
    ds_read_b64_tr_b16 v[46:47], v21 offset:6400
    s_waitcnt lgkmcnt(7)
    v_mfma_f32_32x32x16_bf16 v[64:79], v[200:203], v[32:35], v[64:79]
    s_waitcnt vmcnt(9)
    s_barrier
    s_mov_b64 exec, 1
    buffer_store_dword v104, off, s[32:35], s57 sc1
    s_mov_b64 exec, -1
    s_add_u32 m0, s42, 98304
    s_add_u32 s3, s3, 128
    s_and_b32 s3, s3, 1023
    s_mul_i32 s45, s3, 1376
    v_subrev_u32 v16, 131072, v16
    ds_read_b128 v[208:211], v16 offset:16384
    v_subrev_u32 v20, 131072, v20
    ds_read_b64_tr_b16 v[32:33], v20 offset:0
    ds_read_b64_tr_b16 v[34:35], v20 offset:256
    buffer_load_dwordx4 v11, s[16:19], s45 offen offset:0 lds
    s_waitcnt lgkmcnt(8)
    v_mfma_f32_32x32x16_bf16 v[80:95], v[200:203], v[36:39], v[80:95]
    v_subrev_u32 v21, 131072, v21
    ds_read_b64_tr_b16 v[36:37], v21 offset:0
    ds_read_b64_tr_b16 v[38:39], v21 offset:256
    s_waitcnt lgkmcnt(7)
    v_mfma_f32_32x32x16_bf16 v[64:79], v[204:207], v[40:43], v[64:79]
    s_add_u32 m0, s42, 99264
    v_subrev_u32 v17, 131072, v17
    ds_read_b128 v[212:215], v17 offset:16384
    ds_read_b64_tr_b16 v[40:41], v20 offset:2048
    ds_read_b64_tr_b16 v[42:43], v20 offset:2304
    buffer_load_dwordx4 v11, s[16:19], s45 offen offset:64 lds
    s_waitcnt lgkmcnt(8)
    v_mfma_f32_32x32x16_bf16 v[80:95], v[204:207], v[44:47], v[80:95]
    ds_read_b64_tr_b16 v[44:45], v21 offset:2048
    ds_read_b64_tr_b16 v[46:47], v21 offset:2304
    s_waitcnt lgkmcnt(7)
    v_mfma_f32_32x32x16_bf16 v[64:79], v[208:211], v[32:35], v[64:79]
    s_add_u32 m0, s42, 100224
    v_subrev_u32 v18, 131072, v18
    ds_read_b128 v[216:219], v18 offset:16384
    ds_read_b64_tr_b16 v[32:33], v20 offset:4096
    ds_read_b64_tr_b16 v[34:35], v20 offset:4352
    buffer_load_dwordx4 v12, s[16:19], s45 offen offset:128 lds
    s_waitcnt lgkmcnt(8)
    v_mfma_f32_32x32x16_bf16 v[80:95], v[208:211], v[36:39], v[80:95]
    ds_read_b64_tr_b16 v[36:37], v21 offset:4096
    ds_read_b64_tr_b16 v[38:39], v21 offset:4352
    s_waitcnt lgkmcnt(7)
    v_mfma_f32_32x32x16_bf16 v[64:79], v[212:215], v[40:43], v[64:79]
    v_subrev_u32 v19, 131072, v19
    ds_read_b128 v[220:223], v19 offset:16384
    ds_read_b64_tr_b16 v[40:41], v20 offset:6144
    ds_read_b64_tr_b16 v[42:43], v20 offset:6400
    s_waitcnt lgkmcnt(8)
    v_mfma_f32_32x32x16_bf16 v[80:95], v[212:215], v[44:47], v[80:95]
    ds_read_b64_tr_b16 v[44:45], v21 offset:6144
    ds_read_b64_tr_b16 v[46:47], v21 offset:6400
    s_waitcnt lgkmcnt(7)
    v_mfma_f32_32x32x16_bf16 v[64:79], v[216:219], v[32:35], v[64:79]
    s_waitcnt vmcnt(8)
    s_barrier
    ds_read_b128 v[224:227], v16 offset:49152
    ds_read_b64_tr_b16 v[32:33], v20 offset:32768
    ds_read_b64_tr_b16 v[34:35], v20 offset:33024
    s_waitcnt lgkmcnt(8)
    v_mfma_f32_32x32x16_bf16 v[80:95], v[216:219], v[36:39], v[80:95]
    ds_read_b64_tr_b16 v[36:37], v21 offset:32768
    ds_read_b64_tr_b16 v[38:39], v21 offset:33024
    s_waitcnt lgkmcnt(7)
    v_mfma_f32_32x32x16_bf16 v[64:79], v[220:223], v[40:43], v[64:79]
    ds_read_b128 v[228:231], v17 offset:49152
    ds_read_b64_tr_b16 v[40:41], v20 offset:34816
    ds_read_b64_tr_b16 v[42:43], v20 offset:35072
    v_dot2_f32_bf16 v1, v96, v100, 0
    v_dot2_f32_bf16 v1, v97, v101, v1
    v_dot2_f32_bf16 v1, v98, v102, v1
    v_dot2_f32_bf16 v1, v99, v103, v1
    s_waitcnt lgkmcnt(8)
    v_mfma_f32_32x32x16_bf16 v[80:95], v[220:223], v[44:47], v[80:95]
    ds_read_b64_tr_b16 v[44:45], v21 offset:34816
    ds_read_b64_tr_b16 v[46:47], v21 offset:35072
    v_add_f32_dpp v1, v1, v1 row_shr:1 bound_ctrl:1
    s_waitcnt lgkmcnt(7)
    v_mfma_f32_32x32x16_bf16 v[64:79], v[224:227], v[32:35], v[64:79]
    ds_read_b128 v[232:235], v18 offset:49152
    ds_read_b64_tr_b16 v[32:33], v20 offset:36864
    ds_read_b64_tr_b16 v[34:35], v20 offset:37120
    v_add_f32_dpp v1, v1, v1 row_shr:2 bound_ctrl:1
    s_waitcnt lgkmcnt(8)
    v_mfma_f32_32x32x16_bf16 v[80:95], v[224:227], v[36:39], v[80:95]
    ds_read_b64_tr_b16 v[36:37], v21 offset:36864
    ds_read_b64_tr_b16 v[38:39], v21 offset:37120
    v_add_f32_dpp v1, v1, v1 row_shr:4 bound_ctrl:1
    s_waitcnt lgkmcnt(7)
    v_mfma_f32_32x32x16_bf16 v[64:79], v[228:231], v[40:43], v[64:79]
    ds_read_b128 v[236:239], v19 offset:49152
    ds_read_b64_tr_b16 v[40:41], v20 offset:38912
    ds_read_b64_tr_b16 v[42:43], v20 offset:39168
    v_add_f32_dpp v1, v1, v1 row_shr:8 bound_ctrl:1
    s_waitcnt lgkmcnt(8)
    v_mfma_f32_32x32x16_bf16 v[80:95], v[228:231], v[44:47], v[80:95]
    ds_read_b64_tr_b16 v[44:45], v21 offset:38912
    ds_read_b64_tr_b16 v[46:47], v21 offset:39168
    v_add_f32_dpp v1, v1, v1 row_bcast:15 row_mask:0xa
    s_waitcnt lgkmcnt(7)
    v_mfma_f32_32x32x16_bf16 v[64:79], v[232:235], v[32:35], v[64:79]
    s_waitcnt vmcnt(4)
    s_barrier
    s_add_u32 m0, s42, 131072
    s_add_u32 s3, s3, 128
    s_and_b32 s3, s3, 1023
    s_mul_i32 s45, s3, 1376
    v_add_u32 v16, 65536, v16
    ds_read_b128 v[240:243], v16 offset:16384
    v_add_u32 v20, 65536, v20
    ds_read_b64_tr_b16 v[32:33], v20 offset:0
    ds_read_b64_tr_b16 v[34:35], v20 offset:256
    buffer_load_dwordx4 v11, s[16:19], s45 offen offset:0 lds
    v_add_f32_dpp v1, v1, v1 row_bcast:31 row_mask:0xc
    s_waitcnt lgkmcnt(8)
    v_mfma_f32_32x32x16_bf16 v[80:95], v[232:235], v[36:39], v[80:95]
    v_add_u32 v21, 65536, v21
    ds_read_b64_tr_b16 v[36:37], v21 offset:0
    ds_read_b64_tr_b16 v[38:39], v21 offset:256
    v_mul_f32 v1, 0xbfb8aa3b, v1
    v_exp_f32 v1, v1
    s_waitcnt lgkmcnt(7)
    v_mfma_f32_32x32x16_bf16 v[64:79], v[236:239], v[40:43], v[64:79]
    s_add_u32 m0, s42, 132032
    v_add_u32 v17, 65536, v17
    ds_read_b128 v[244:247], v17 offset:16384
    ds_read_b64_tr_b16 v[40:41], v20 offset:2048
    ds_read_b64_tr_b16 v[42:43], v20 offset:2304
    buffer_load_dwordx4 v11, s[16:19], s45 offen offset:64 lds
    v_add_f32 v1, 1.0, v1
    v_rcp_f32 v1, v1
    s_waitcnt lgkmcnt(8)
    v_mfma_f32_32x32x16_bf16 v[80:95], v[236:239], v[44:47], v[80:95]
    ds_read_b64_tr_b16 v[44:45], v21 offset:2048
    ds_read_b64_tr_b16 v[46:47], v21 offset:2304
    v_min_u32 v1, -2, v1
    s_waitcnt lgkmcnt(7)
    v_mfma_f32_32x32x16_bf16 v[64:79], v[240:243], v[32:35], v[64:79]
    s_add_u32 m0, s42, 132992
    v_add_u32 v18, 65536, v18
    ds_read_b128 v[248:251], v18 offset:16384
    ds_read_b64_tr_b16 v[32:33], v20 offset:4096
    ds_read_b64_tr_b16 v[34:35], v20 offset:4352
    buffer_load_dwordx4 v12, s[16:19], s45 offen offset:128 lds
    v_readlane_b32 s60, v1, 63
    s_waitcnt lgkmcnt(8)
    v_mfma_f32_32x32x16_bf16 v[80:95], v[240:243], v[36:39], v[80:95]
    ds_read_b64_tr_b16 v[36:37], v21 offset:4096
    ds_read_b64_tr_b16 v[38:39], v21 offset:4352
    s_waitcnt lgkmcnt(7)
    v_mfma_f32_32x32x16_bf16 v[64:79], v[244:247], v[40:43], v[64:79]
    v_add_u32 v19, 65536, v19
    ds_read_b128 v[252:255], v19 offset:16384
    ds_read_b64_tr_b16 v[40:41], v20 offset:6144
    ds_read_b64_tr_b16 v[42:43], v20 offset:6400
    s_waitcnt lgkmcnt(8)
    v_mfma_f32_32x32x16_bf16 v[80:95], v[244:247], v[44:47], v[80:95]
    ds_read_b64_tr_b16 v[44:45], v21 offset:6144
    ds_read_b64_tr_b16 v[46:47], v21 offset:6400
    s_waitcnt lgkmcnt(7)
    v_mfma_f32_32x32x16_bf16 v[64:79], v[248:251], v[32:35], v[64:79]
    s_waitcnt vmcnt(3)
    s_barrier
    buffer_load_dword v14, v15, s[32:35], s69 offen sc1
    s_add_u32 m0, s42, 0
    s_add_u32 s3, s3, 128
    s_and_b32 s3, s3, 1023
    s_mul_i32 s45, s3, 1376
    ds_read_b64_tr_b16 v[32:33], v8 offset:32768
    ds_read_b64_tr_b16 v[34:35], v8 offset:33024
    buffer_load_dwordx4 v11, s[16:19], s45 offen offset:0 lds
    s_waitcnt lgkmcnt(7)
    v_mfma_f32_32x32x16_bf16 v[80:95], v[248:251], v[36:39], v[80:95]
    s_add_u32 m0, s42, 960
    ds_read_b64_tr_b16 v[36:37], v9 offset:32768
    ds_read_b64_tr_b16 v[38:39], v9 offset:33024
    buffer_load_dwordx4 v11, s[16:19], s45 offen offset:64 lds
    s_waitcnt lgkmcnt(6)
    v_mfma_f32_32x32x16_bf16 v[64:79], v[252:255], v[40:43], v[64:79]
    s_add_u32 m0, s42, 1920
    ds_read_b64_tr_b16 v[40:41], v8 offset:35840
    ds_read_b64_tr_b16 v[42:43], v8 offset:36096
    buffer_load_dwordx4 v12, s[16:19], s45 offen offset:128 lds
    s_waitcnt lgkmcnt(6)
    v_mfma_f32_32x32x16_bf16 v[80:95], v[252:255], v[44:47], v[80:95]
    ds_read_b64_tr_b16 v[44:45], v9 offset:35840
    ds_read_b64_tr_b16 v[46:47], v9 offset:36096
    s_branch KF_P2
KF_P2A:
    s_waitcnt lgkmcnt(6)
    v_mfma_f32_32x32x16_bf16 v[96:111], v[32:35], v[128:131], 0
    ds_read_b64_tr_b16 v[32:33], v8 offset:34816
    ds_read_b64_tr_b16 v[34:35], v8 offset:35072
    s_waitcnt lgkmcnt(6)
    v_mfma_f32_32x32x16_bf16 v[112:127], v[36:39], v[128:131], 0
    ds_read_b64_tr_b16 v[36:37], v8 offset:37888
    ds_read_b64_tr_b16 v[38:39], v8 offset:38144
    v_cvt_pk_bf16_f32 v64, v64, v65
    v_cvt_pk_bf16_f32 v65, v66, v67
    s_waitcnt lgkmcnt(6)
    v_mfma_f32_32x32x16_bf16 v[96:111], v[40:43], v[132:135], v[96:111]
    ds_read_b64_tr_b16 v[40:41], v8 offset:38912
    ds_read_b64_tr_b16 v[42:43], v8 offset:39168
    v_cvt_pk_bf16_f32 v66, v68, v69
    v_cvt_pk_bf16_f32 v67, v70, v71
    s_waitcnt lgkmcnt(6)
    v_mfma_f32_32x32x16_bf16 v[112:127], v[44:47], v[132:135], v[112:127]
    ds_read_b64_tr_b16 v[44:45], v9 offset:38912
    ds_read_b64_tr_b16 v[46:47], v9 offset:39168
    buffer_store_dwordx4 v[64:67], v7, s[4:7], s46 offen sc1
    v_cvt_pk_bf16_f32 v72, v72, v73
    s_waitcnt lgkmcnt(6)
    v_mfma_f32_32x32x16_bf16 v[16:31], v[32:35], v[128:131], 0
    ds_read_b64_tr_b16 v[32:33], v8 offset:40960
    ds_read_b64_tr_b16 v[34:35], v8 offset:41216
    v_cvt_pk_bf16_f32 v73, v74, v75
    v_cvt_pk_bf16_f32 v74, v76, v77
    s_waitcnt lgkmcnt(6)
    v_mfma_f32_32x32x16_bf16 v[16:31], v[36:39], v[132:135], v[16:31]
    ds_read_b64_tr_b16 v[36:37], v8 offset:41984
    ds_read_b64_tr_b16 v[38:39], v8 offset:42240
    v_cvt_pk_bf16_f32 v75, v78, v79
    s_add_u32 s74, s46, s47
    buffer_store_dwordx4 v[72:75], v7, s[4:7], s74 offen sc1
    s_waitcnt lgkmcnt(6)
    v_mfma_f32_32x32x16_bf16 v[96:111], v[40:43], v[136:139], v[96:111]
    s_waitcnt vmcnt(6)
    s_barrier
    ds_read_b64_tr_b16 v[40:41], v9 offset:41984
    ds_read_b64_tr_b16 v[42:43], v9 offset:42240
    v_cvt_pk_bf16_f32 v80, v80, v81
    s_waitcnt lgkmcnt(6)
    v_mfma_f32_32x32x16_bf16 v[112:127], v[44:47], v[136:139], v[112:127]
    ds_read_b64_tr_b16 v[44:45], v8 offset:44032
    ds_read_b64_tr_b16 v[46:47], v8 offset:44288
    v_cvt_pk_bf16_f32 v81, v82, v83
    v_cvt_pk_bf16_f32 v82, v84, v85
    s_waitcnt lgkmcnt(6)
    v_mfma_f32_32x32x16_bf16 v[16:31], v[32:35], v[136:139], v[16:31]
    v_add_u32 v8, 65536, v8
    ds_read_b64_tr_b16 v[32:33], v8 offset:0
    ds_read_b64_tr_b16 v[34:35], v8 offset:256
    v_cvt_pk_bf16_f32 v83, v86, v87
    s_add_u32 s46, s46, 0x20000
    buffer_store_dwordx4 v[80:83], v7, s[4:7], s46 offen sc1
    s_waitcnt lgkmcnt(6)
    v_mfma_f32_32x32x16_bf16 v[96:111], v[36:39], v[140:143], v[96:111]
    v_add_u32 v9, 65536, v9
    ds_read_b64_tr_b16 v[36:37], v9 offset:0
    ds_read_b64_tr_b16 v[38:39], v9 offset:256
    v_cvt_pk_bf16_f32 v88, v88, v89
    v_cvt_pk_bf16_f32 v89, v90, v91
    s_waitcnt lgkmcnt(6)
    v_mfma_f32_32x32x16_bf16 v[112:127], v[40:43], v[140:143], v[112:127]
    ds_read_b64_tr_b16 v[40:41], v8 offset:2048
    ds_read_b64_tr_b16 v[42:43], v8 offset:2304
    v_cvt_pk_bf16_f32 v90, v92, v93
    v_cvt_pk_bf16_f32 v91, v94, v95
    s_waitcnt lgkmcnt(6)
    v_mfma_f32_32x32x16_bf16 v[16:31], v[44:47], v[140:143], v[16:31]
    ds_read_b64_tr_b16 v[44:45], v8 offset:3072
    ds_read_b64_tr_b16 v[46:47], v8 offset:3328
    s_add_u32 s74, s46, s47
    buffer_store_dwordx4 v[88:91], v7, s[4:7], s74 offen sc1
    s_waitcnt lgkmcnt(6)
    v_mfma_f32_32x32x16_bf16 v[96:111], v[32:35], v[144:147], v[96:111]
    s_add_u32 m0, s42, 32768
    s_add_u32 s3, s3, 128
    s_and_b32 s3, s3, 1023
    s_mul_i32 s45, s3, 1376
    ds_read_b64_tr_b16 v[32:33], v9 offset:3072
    ds_read_b64_tr_b16 v[34:35], v9 offset:3328
    buffer_load_dwordx4 v11, s[16:19], s45 offen offset:0 lds
    s_waitcnt lgkmcnt(6)
    v_mfma_f32_32x32x16_bf16 v[112:127], v[36:39], v[144:147], v[112:127]
    s_add_u32 m0, s42, 33728
    ds_read_b64_tr_b16 v[36:37], v8 offset:5120
    ds_read_b64_tr_b16 v[38:39], v8 offset:5376
    buffer_load_dwordx4 v11, s[16:19], s45 offen offset:64 lds
    s_waitcnt lgkmcnt(6)
    v_mfma_f32_32x32x16_bf16 v[16:31], v[40:43], v[144:147], v[16:31]
    ds_read_b64_tr_b16 v[40:41], v8 offset:6144
    ds_read_b64_tr_b16 v[42:43], v8 offset:6400
    s_waitcnt lgkmcnt(6)
    v_mfma_f32_32x32x16_bf16 v[96:111], v[44:47], v[148:151], v[96:111]
    s_add_u32 m0, s42, 34688
    ds_read_b64_tr_b16 v[44:45], v9 offset:6144
    ds_read_b64_tr_b16 v[46:47], v9 offset:6400
    buffer_load_dwordx4 v12, s[16:19], s45 offen offset:128 lds
    s_waitcnt lgkmcnt(6)
    v_mfma_f32_32x32x16_bf16 v[112:127], v[32:35], v[148:151], v[112:127]
    ds_read_b64_tr_b16 v[32:33], v8 offset:8192
    ds_read_b64_tr_b16 v[34:35], v8 offset:8448
    s_waitcnt lgkmcnt(6)
    v_mfma_f32_32x32x16_bf16 v[16:31], v[36:39], v[148:151], v[16:31]
    ds_read_b64_tr_b16 v[36:37], v8 offset:9216
    ds_read_b64_tr_b16 v[38:39], v8 offset:9472
    s_waitcnt lgkmcnt(6)
    v_mfma_f32_32x32x16_bf16 v[96:111], v[40:43], v[152:155], v[96:111]
    s_waitcnt vmcnt(7)
    s_barrier
    s_add_u32 m0, s42, 65536
    s_add_u32 s3, s3, 128
    s_and_b32 s3, s3, 1023
    s_mul_i32 s45, s3, 1376
    ds_read_b64_tr_b16 v[40:41], v9 offset:9216
    ds_read_b64_tr_b16 v[42:43], v9 offset:9472
    buffer_load_dwordx4 v11, s[16:19], s45 offen offset:0 lds
    s_waitcnt lgkmcnt(6)
    v_mfma_f32_32x32x16_bf16 v[112:127], v[44:47], v[152:155], v[112:127]
    ds_read_b64_tr_b16 v[44:45], v8 offset:11264
    ds_read_b64_tr_b16 v[46:47], v8 offset:11520
    s_waitcnt lgkmcnt(6)
    v_mfma_f32_32x32x16_bf16 v[16:31], v[32:35], v[152:155], v[16:31]
    v_subrev_u32 v8, 131072, v8
    ds_read_b64_tr_b16 v[32:33], v8 offset:0
    ds_read_b64_tr_b16 v[34:35], v8 offset:256
    s_waitcnt lgkmcnt(6)
    v_mfma_f32_32x32x16_bf16 v[96:111], v[36:39], v[156:159], v[96:111]
    s_add_u32 m0, s42, 66496
    v_subrev_u32 v9, 131072, v9
    ds_read_b64_tr_b16 v[36:37], v9 offset:0
    ds_read_b64_tr_b16 v[38:39], v9 offset:256
    buffer_load_dwordx4 v11, s[16:19], s45 offen offset:64 lds
    s_waitcnt lgkmcnt(6)
    v_mfma_f32_32x32x16_bf16 v[112:127], v[40:43], v[156:159], v[112:127]
    ds_read_b64_tr_b16 v[40:41], v8 offset:2048
    ds_read_b64_tr_b16 v[42:43], v8 offset:2304
    s_waitcnt lgkmcnt(6)
    v_mfma_f32_32x32x16_bf16 v[16:31], v[44:47], v[156:159], v[16:31]
    ds_read_b64_tr_b16 v[44:45], v8 offset:3072
    ds_read_b64_tr_b16 v[46:47], v8 offset:3328
    s_waitcnt lgkmcnt(6)
    v_mfma_f32_32x32x16_bf16 v[96:111], v[32:35], v[160:163], v[96:111]
    s_add_u32 m0, s42, 67456
    ds_read_b64_tr_b16 v[32:33], v9 offset:3072
    ds_read_b64_tr_b16 v[34:35], v9 offset:3328
    buffer_load_dwordx4 v12, s[16:19], s45 offen offset:128 lds
    s_waitcnt lgkmcnt(6)
    v_mfma_f32_32x32x16_bf16 v[112:127], v[36:39], v[160:163], v[112:127]
    ds_read_b64_tr_b16 v[36:37], v8 offset:5120
    ds_read_b64_tr_b16 v[38:39], v8 offset:5376
    s_waitcnt lgkmcnt(6)
    v_mfma_f32_32x32x16_bf16 v[16:31], v[40:43], v[160:163], v[16:31]
    ds_read_b64_tr_b16 v[40:41], v8 offset:6144
    ds_read_b64_tr_b16 v[42:43], v8 offset:6400
    s_waitcnt lgkmcnt(6)
    v_mfma_f32_32x32x16_bf16 v[96:111], v[44:47], v[164:167], v[96:111]
    s_add_u32 m0, s42, 98304
    s_add_u32 s3, s3, 128
    s_and_b32 s3, s3, 1023
    s_mul_i32 s45, s3, 1376
    ds_read_b64_tr_b16 v[44:45], v9 offset:6144
    ds_read_b64_tr_b16 v[46:47], v9 offset:6400
    buffer_load_dwordx4 v11, s[16:19], s45 offen offset:0 lds
    s_waitcnt lgkmcnt(6)
    v_mfma_f32_32x32x16_bf16 v[112:127], v[32:35], v[164:167], v[112:127]
    ds_read_b64_tr_b16 v[32:33], v8 offset:8192
    ds_read_b64_tr_b16 v[34:35], v8 offset:8448
    s_waitcnt lgkmcnt(6)
    v_mfma_f32_32x32x16_bf16 v[16:31], v[36:39], v[164:167], v[16:31]
    ds_read_b64_tr_b16 v[36:37], v8 offset:9216
    ds_read_b64_tr_b16 v[38:39], v8 offset:9472
    s_waitcnt lgkmcnt(6)
    v_mfma_f32_32x32x16_bf16 v[96:111], v[40:43], v[168:171], v[96:111]
    s_waitcnt vmcnt(4)
    v_cmp_eq_u32 vcc, s40, v14
    s_cmp_lg_u64 vcc, 0
    s_cbranch_scc1 S0A_SP
S0A_OK:
    s_barrier
    s_mov_b64 exec, 1
    buffer_store_dword v2, off, s[4:7], s56 sc1
    s_mov_b64 exec, -1
    s_add_u32 m0, s42, 99264
    ds_read_b64_tr_b16 v[40:41], v9 offset:9216
    ds_read_b64_tr_b16 v[42:43], v9 offset:9472
    buffer_load_dwordx4 v11, s[16:19], s45 offen offset:64 lds
    s_waitcnt lgkmcnt(6)
    v_mfma_f32_32x32x16_bf16 v[112:127], v[44:47], v[168:171], v[112:127]
    ds_read_b64_tr_b16 v[44:45], v8 offset:11264
    ds_read_b64_tr_b16 v[46:47], v8 offset:11520
    s_waitcnt lgkmcnt(6)
    v_mfma_f32_32x32x16_bf16 v[16:31], v[32:35], v[168:171], v[16:31]
    ds_read_b64_tr_b16 v[32:33], v8 offset:32768
    ds_read_b64_tr_b16 v[34:35], v8 offset:33024
    s_waitcnt lgkmcnt(6)
    v_mfma_f32_32x32x16_bf16 v[96:111], v[36:39], v[172:175], v[96:111]
    s_add_u32 m0, s42, 100224
    ds_read_b64_tr_b16 v[36:37], v9 offset:32768
    ds_read_b64_tr_b16 v[38:39], v9 offset:33024
    buffer_load_dwordx4 v12, s[16:19], s45 offen offset:128 lds
    s_lshr_b32 s54, s40, 1
    s_lshl1_add_u32 s54, s71, s54
    s_waitcnt lgkmcnt(6)
    v_mfma_f32_32x32x16_bf16 v[112:127], v[40:43], v[172:175], v[112:127]
    ds_read_b64_tr_b16 v[40:41], v8 offset:34816
    ds_read_b64_tr_b16 v[42:43], v8 offset:35072
    v_and_b32 v0, 3, v2
    s_waitcnt lgkmcnt(6)
    v_mfma_f32_32x32x16_bf16 v[16:31], v[44:47], v[172:175], v[16:31]
    ds_read_b64_tr_b16 v[44:45], v8 offset:35840
    ds_read_b64_tr_b16 v[46:47], v8 offset:36096
    v_lshl_add_u32 v0, v0, 2, s54
    s_waitcnt lgkmcnt(6)
    v_mfma_f32_32x32x16_bf16 v[96:111], v[32:35], v[176:179], v[96:111]
    s_add_u32 m0, s42, 131072
    s_add_u32 s3, s3, 128
    s_and_b32 s3, s3, 1023
    s_mul_i32 s45, s3, 1376
    ds_read_b64_tr_b16 v[32:33], v9 offset:35840
    ds_read_b64_tr_b16 v[34:35], v9 offset:36096
    buffer_load_dwordx4 v11, s[16:19], s45 offen offset:0 lds
    v_and_b32 v0, 15, v0
    s_waitcnt lgkmcnt(6)
    v_mfma_f32_32x32x16_bf16 v[112:127], v[36:39], v[176:179], v[112:127]
    ds_read_b64_tr_b16 v[36:37], v8 offset:37888
    ds_read_b64_tr_b16 v[38:39], v8 offset:38144
    v_and_b32 v1, 4, v2
    s_waitcnt lgkmcnt(6)
    v_mfma_f32_32x32x16_bf16 v[16:31], v[40:43], v[176:179], v[16:31]
    ds_read_b64_tr_b16 v[40:41], v8 offset:38912
    ds_read_b64_tr_b16 v[42:43], v8 offset:39168
    v_lshlrev_b32 v0, 7, v0
    v_lshl_add_u32 v0, v1, 3, v0
    s_waitcnt lgkmcnt(6)
    v_mfma_f32_32x32x16_bf16 v[96:111], v[44:47], v[180:183], v[96:111]
    s_add_u32 m0, s42, 132032
    ds_read_b64_tr_b16 v[44:45], v9 offset:38912
    ds_read_b64_tr_b16 v[46:47], v9 offset:39168
    buffer_load_dwordx4 v11, s[16:19], s45 offen offset:64 lds
    v_add_u32 v0, 32, v0
    s_waitcnt lgkmcnt(6)
    v_mfma_f32_32x32x16_bf16 v[112:127], v[32:35], v[180:183], v[112:127]
    ds_read_b64_tr_b16 v[32:33], v8 offset:40960
    ds_read_b64_tr_b16 v[34:35], v8 offset:41216
    s_mov_b64 vcc, 0xff
    s_waitcnt lgkmcnt(6)
    v_mfma_f32_32x32x16_bf16 v[16:31], v[36:39], v[180:183], v[16:31]
    ds_read_b64_tr_b16 v[36:37], v8 offset:41984
    ds_read_b64_tr_b16 v[38:39], v8 offset:42240
    v_cndmask_b32 v0, 1073741824, v0, vcc
    s_waitcnt lgkmcnt(6)
    v_mfma_f32_32x32x16_bf16 v[96:111], v[40:43], v[184:187], v[96:111]
    s_waitcnt vmcnt(6)
    s_barrier
    s_add_u32 m0, s42, 132992
    ds_read_b64_tr_b16 v[40:41], v9 offset:41984
    ds_read_b64_tr_b16 v[42:43], v9 offset:42240
    buffer_load_dwordx4 v12, s[16:19], s45 offen offset:128 lds
    s_lshl1_add_u32 s54, s71, s68
    s_waitcnt lgkmcnt(6)
    v_mfma_f32_32x32x16_bf16 v[112:127], v[44:47], v[184:187], v[112:127]
    ds_read_b64_tr_b16 v[44:45], v8 offset:44032
    ds_read_b64_tr_b16 v[46:47], v8 offset:44288
    s_lshl_b32 s54, s54, 7
    v_writelane_b32 v0, s54, 8
    s_waitcnt lgkmcnt(6)
    v_mfma_f32_32x32x16_bf16 v[16:31], v[32:35], v[184:187], v[16:31]
    v_add_u32 v8, 65536, v8
    ds_read_b64_tr_b16 v[32:33], v8 offset:0
    ds_read_b64_tr_b16 v[34:35], v8 offset:256
    s_bfe_u32 s62, s70, 0x20001
    s_waitcnt lgkmcnt(6)
    v_mfma_f32_32x32x16_bf16 v[96:111], v[36:39], v[188:191], v[96:111]
    s_add_u32 m0, s42, 0
    s_add_u32 s3, s3, 128
    s_and_b32 s3, s3, 1023
    s_mul_i32 s45, s3, 1376
    v_add_u32 v9, 65536, v9
    ds_read_b64_tr_b16 v[36:37], v9 offset:0
    ds_read_b64_tr_b16 v[38:39], v9 offset:256
    buffer_load_dwordx4 v11, s[16:19], s45 offen offset:0 lds
    s_lshl_b32 s62, s62, 5
    s_waitcnt lgkmcnt(6)
    v_mfma_f32_32x32x16_bf16 v[112:127], v[40:43], v[188:191], v[112:127]
    s_add_u32 m0, s42, 960
    ds_read_b64_tr_b16 v[40:41], v8 offset:2048
    ds_read_b64_tr_b16 v[42:43], v8 offset:2304
    buffer_load_dwordx4 v11, s[16:19], s45 offen offset:64 lds
    s_add_u32 s54, s54, s62
    s_waitcnt lgkmcnt(6)
    v_mfma_f32_32x32x16_bf16 v[16:31], v[44:47], v[188:191], v[16:31]
    ds_read_b64_tr_b16 v[44:45], v8 offset:3072
    ds_read_b64_tr_b16 v[46:47], v8 offset:3328
    v_writelane_b32 v0, s54, 9
    s_waitcnt lgkmcnt(6)
    v_mfma_f32_32x32x16_bf16 v[96:111], v[32:35], v[192:195], v[96:111]
    s_add_u32 m0, s42, 1920
    ds_read_b64_tr_b16 v[32:33], v9 offset:3072
    ds_read_b64_tr_b16 v[34:35], v9 offset:3328
    buffer_load_dwordx4 v12, s[16:19], s45 offen offset:128 lds
    s_waitcnt lgkmcnt(6)
    v_mfma_f32_32x32x16_bf16 v[112:127], v[36:39], v[192:195], v[112:127]
    ds_read_b64_tr_b16 v[36:37], v8 offset:5120
    ds_read_b64_tr_b16 v[38:39], v8 offset:5376
    s_waitcnt lgkmcnt(6)
    v_mfma_f32_32x32x16_bf16 v[16:31], v[40:43], v[192:195], v[16:31]
    ds_read_b64_tr_b16 v[40:41], v8 offset:6144
    ds_read_b64_tr_b16 v[42:43], v8 offset:6400
    s_waitcnt lgkmcnt(6)
    v_mfma_f32_32x32x16_bf16 v[96:111], v[44:47], v[196:199], v[96:111]
    ds_read_b64_tr_b16 v[44:45], v9 offset:6144
    ds_read_b64_tr_b16 v[46:47], v9 offset:6400
    v_lshrrev_b32 v3, 3, v2
    v_and_b32 v4, 7, v2
    v_lshlrev_b32 v4, 4, v4
    v_and_b32 v5, 16, v2
    v_lshlrev_b32 v14, 2, v5
    s_waitcnt lgkmcnt(6)
    v_mfma_f32_32x32x16_bf16 v[112:127], v[32:35], v[196:199], v[112:127]
    ds_read_b64_tr_b16 v[32:33], v8 offset:8192
    ds_read_b64_tr_b16 v[34:35], v8 offset:8448
    v_xor_b32 v4, v4, v14
    v_lshl_add_u32 v14, v3, 10, v4
    s_lshl_b32 s74, s71, 7
    v_add_u32 v14, s74, v14
    s_waitcnt lgkmcnt(6)
    v_mfma_f32_32x32x16_bf16 v[16:31], v[36:39], v[196:199], v[16:31]
    ds_read_b64_tr_b16 v[36:37], v8 offset:9216
    ds_read_b64_tr_b16 v[38:39], v8 offset:9472
    s_lshl_b32 s43, s40, 14
    v_lshrrev_b32 v3, 5, v2
    v_bfe_u32 v4, v2, 2, 2
    v_lshl_add_u32 v4, v3, 3, v4
    s_waitcnt lgkmcnt(6)
    v_mfma_f32_32x32x16_bf16 v[96:111], v[40:43], v[200:203], v[96:111]
    s_waitcnt vmcnt(6)
    s_barrier
    ds_read_b64_tr_b16 v[40:41], v9 offset:9216
    ds_read_b64_tr_b16 v[42:43], v9 offset:9472
    v_lshlrev_b32 v4, 7, v4
    v_lshl_add_u32 v4, v5, 1, v4
    v_and_b32 v5, 1, v2
    v_lshl_add_u32 v4, v5, 4, v4
    s_waitcnt lgkmcnt(6)
    v_mfma_f32_32x32x16_bf16 v[112:127], v[44:47], v[200:203], v[112:127]
    ds_read_b64_tr_b16 v[44:45], v8 offset:11264
    ds_read_b64_tr_b16 v[46:47], v8 offset:11520
    v_and_b32 v5, 2, v2
    v_lshl_add_u32 v4, v5, 2, v4
    v_and_b32 v5, 8, v2
    v_lshl_add_u32 v4, v5, 3, v4
    s_waitcnt lgkmcnt(6)
    v_mfma_f32_32x32x16_bf16 v[16:31], v[32:35], v[200:203], v[16:31]
    ds_read_b64_tr_b16 v[32:33], v8 offset:32768
    ds_read_b64_tr_b16 v[34:35], v8 offset:33024
    s_lshr_b32 s74, s40, 1
    s_lshl_b32 s42, s74, 17
    s_lshl_b32 s75, s74, 5
    s_add_u32 s75, s75, s69
    s_waitcnt lgkmcnt(6)
    v_mfma_f32_32x32x16_bf16 v[96:111], v[36:39], v[204:207], v[96:111]
    ds_read_b64_tr_b16 v[36:37], v9 offset:32768
    ds_read_b64_tr_b16 v[38:39], v9 offset:33024
    v_xor_b32 v4, s75, v4
    v_xor_b32 v5, 64, v4
    v_and_b32 v1, 15, v2
    v_lshlrev_b32 v1, 4, v1
    s_waitcnt lgkmcnt(6)
    v_mfma_f32_32x32x16_bf16 v[112:127], v[40:43], v[204:207], v[112:127]
    ds_read_b64_tr_b16 v[40:41], v8 offset:34816
    ds_read_b64_tr_b16 v[42:43], v8 offset:35072
    v_lshl_add_u32 v12, v3, 8, v1
    v_add_u32 v12, 0x8800, v12
    v_add_u32 v13, 0x10000, v12
    s_lshl_b32 s74, s74, 3
    s_waitcnt lgkmcnt(6)
    v_mfma_f32_32x32x16_bf16 v[16:31], v[44:47], v[204:207], v[16:31]
    ds_read_b64_tr_b16 v[44:45], v8 offset:35840
    ds_read_b64_tr_b16 v[46:47], v8 offset:36096
    s_and_b32 s75, s40, 1
    s_lshl1_add_u32 s75, s70, s75
    s_mul_i32 s44, s75, 86
    s_add_u32 s44, s44, s40
    s_waitcnt lgkmcnt(6)
    v_mfma_f32_32x32x16_bf16 v[96:111], v[32:35], v[208:211], v[96:111]
    ds_read_b64_tr_b16 v[32:33], v9 offset:35840
    ds_read_b64_tr_b16 v[34:35], v9 offset:36096
    s_lshl_b32 s44, s44, 10
    s_add_u32 s44, s44, 6291456
    s_xor_b32 s45, s75, 1
    s_mul_i32 s45, s45, 86
    s_waitcnt lgkmcnt(6)
    v_mfma_f32_32x32x16_bf16 v[112:127], v[36:39], v[208:211], v[112:127]
    ds_read_b64_tr_b16 v[36:37], v8 offset:37888
    ds_read_b64_tr_b16 v[38:39], v8 offset:38144
    s_add_u32 s45, s45, s40
    s_lshl_b32 s45, s45, 10
    s_add_u32 s45, s45, 6291456
    s_lshl_b32 s46, s72, 5
    s_waitcnt lgkmcnt(6)
    v_mfma_f32_32x32x16_bf16 v[16:31], v[40:43], v[208:211], v[16:31]
    ds_read_b64_tr_b16 v[40:41], v8 offset:40960
    ds_read_b64_tr_b16 v[42:43], v8 offset:41216
    s_add_u32 s46, s46, s70
    s_lshl_b32 s46, s46, 10
    s_add_u32 s46, s46, 12582912
    s_lshl_b32 s47, s75, 5
    s_waitcnt lgkmcnt(6)
    v_mfma_f32_32x32x16_bf16 v[96:111], v[44:47], v[212:215], v[96:111]
    ds_read_b64_tr_b16 v[44:45], v8 offset:44032
    ds_read_b64_tr_b16 v[46:47], v8 offset:44288
    s_add_u32 s47, s47, s74
    s_lshl_b32 s47, s47, 10
    s_add_u32 s47, s47, 12582912
    s_add_u32 s48, s47, 4096
    s_lshl_b32 s51, s72, 7
    s_waitcnt lgkmcnt(6)
    v_mfma_f32_32x32x16_bf16 v[112:127], v[32:35], v[212:215], v[112:127]
    s_waitcnt vmcnt(0)
    s_barrier
    v_add_u32 v8, 65536, v8
    ds_read_b64_tr_b16 v[32:33], v8 offset:2048
    ds_read_b64_tr_b16 v[34:35], v8 offset:2304
    s_add_u32 s51, s51, 16777216
    s_lshl_b32 s52, s75, 7
    s_add_u32 s52, s52, 16777216
    s_xor_b32 s53, s52, 128
    s_waitcnt lgkmcnt(6)
    v_mfma_f32_32x32x16_bf16 v[16:31], v[36:39], v[212:215], v[16:31]
    ds_read_b64_tr_b16 v[36:37], v8 offset:5120
    ds_read_b64_tr_b16 v[38:39], v8 offset:5376
    s_mul_i32 s55, s70, 176128
    s_add_u32 s55, s55, 6291456
    s_mul_i32 s59, s72, 2816
    s_mov_b32 s56, 0xffff
    s_waitcnt lgkmcnt(6)
    v_mfma_f32_32x32x16_bf16 v[16:31], v[40:43], v[216:219], v[16:31]
    ds_read_b64_tr_b16 v[40:41], v8 offset:8192
    ds_read_b64_tr_b16 v[42:43], v8 offset:8448
    s_mov_b32 s57, 0xffff
    v_add_u32 v7, 0x8000, v10
    v_add_u32 v11, 0x18000, v10
    v_add_u32 v131, s69, v7
    s_waitcnt lgkmcnt(6)
    v_mfma_f32_32x32x16_bf16 v[16:31], v[44:47], v[220:223], v[16:31]
    ds_read_b64_tr_b16 v[44:45], v8 offset:11264
    ds_read_b64_tr_b16 v[46:47], v8 offset:11520
    v_mov_b32 v132, v6
    v_mov_b32 v133, 0xc0135761
    v_mov_b32 v15, 0xdddd
    v_and_b32 v1, 31, v2
    s_waitcnt lgkmcnt(6)
    v_mfma_f32_32x32x16_bf16 v[16:31], v[32:35], v[224:227], v[16:31]
    v_subrev_u32 v8, 131072, v8
    ds_read_b64_tr_b16 v[32:33], v8 offset:2048
    ds_read_b64_tr_b16 v[34:35], v8 offset:2304
    v_lshlrev_b32 v1, 2, v1
    v_mov_b32 v56, 0
    s_mov_b32 exec_lo, 0x110000
    s_mov_b32 exec_hi, 0x110000
    v_mov_b32 v56, 0x3f803f80
    s_mov_b64 exec, -1
    v_mov_b32 v57, v56
    s_waitcnt lgkmcnt(6)
    v_mfma_f32_32x32x16_bf16 v[16:31], v[36:39], v[228:231], v[16:31]
    ds_read_b64_tr_b16 v[36:37], v8 offset:5120
    ds_read_b64_tr_b16 v[38:39], v8 offset:5376
    v_mov_b32 v58, v56
    v_mov_b32 v59, v56
    v_mov_b32 v60, v56
    v_mov_b32 v61, v56
    s_waitcnt lgkmcnt(6)
    v_mfma_f32_32x32x16_bf16 v[16:31], v[40:43], v[232:235], v[16:31]
    ds_read_b64_tr_b16 v[40:41], v8 offset:8192
    ds_read_b64_tr_b16 v[42:43], v8 offset:8448
    v_mov_b32 v62, v56
    v_mov_b32 v63, v56
    v_mov_b32 v64, 0
    v_mov_b32 v65, 0
    s_waitcnt lgkmcnt(6)
    v_mfma_f32_32x32x16_bf16 v[16:31], v[44:47], v[236:239], v[16:31]
    ds_read_b64_tr_b16 v[44:45], v8 offset:11264
    ds_read_b64_tr_b16 v[46:47], v8 offset:11520
    v_mov_b32 v66, 0
    v_mov_b32 v67, 0
    v_mov_b32 v68, 0
    v_mov_b32 v69, 0
    s_waitcnt lgkmcnt(6)
    v_mfma_f32_32x32x16_bf16 v[16:31], v[32:35], v[240:243], v[16:31]
    v_add_u32 v8, 65536, v8
    ds_read_b64_tr_b16 v[32:33], v8 offset:38912
    ds_read_b64_tr_b16 v[34:35], v8 offset:39168
    buffer_load_dword v128, v0, s[4:7], s67 offen sc1
    v_mov_b32 v70, 0
    v_mov_b32 v71, 0
    v_mov_b32 v72, 0
    v_mov_b32 v73, 0
    s_waitcnt lgkmcnt(6)
    v_mfma_f32_32x32x16_bf16 v[16:31], v[36:39], v[244:247], v[16:31]
    ds_read_b64_tr_b16 v[36:37], v8 offset:41984
    ds_read_b64_tr_b16 v[38:39], v8 offset:42240
    v_mov_b32 v74, 0
    v_mov_b32 v75, 0
    v_mov_b32 v76, 0
    v_mov_b32 v77, 0
    s_waitcnt lgkmcnt(6)
    v_mfma_f32_32x32x16_bf16 v[16:31], v[40:43], v[248:251], v[16:31]
    v_add_u32 v8, 65536, v8
    ds_read_b64_tr_b16 v[40:41], v8 offset:0
    ds_read_b64_tr_b16 v[42:43], v8 offset:256
    v_mov_b32 v78, 0
    v_mov_b32 v79, 0
    s_lshl_b32 s75, s73, 17
    s_add_u32 s75, s75, s43
    s_waitcnt lgkmcnt(6)
    v_mfma_f32_32x32x16_bf16 v[16:31], v[44:47], v[252:255], v[16:31]
    ds_read_b64_tr_b16 v[44:45], v8 offset:3072
    ds_read_b64_tr_b16 v[46:47], v8 offset:3328
    s_waitcnt lgkmcnt(6)
    v_mfma_f32_32x32x16_bf16 v[96:111], v[32:35], v[216:219], v[96:111]
    ds_read_b64_tr_b16 v[32:33], v8 offset:6144
    ds_read_b64_tr_b16 v[34:35], v8 offset:6400
    s_waitcnt lgkmcnt(6)
    v_mfma_f32_32x32x16_bf16 v[96:111], v[36:39], v[220:223], v[96:111]
    ds_read_b64_tr_b16 v[36:37], v8 offset:9216
    ds_read_b64_tr_b16 v[38:39], v8 offset:9472
    s_waitcnt lgkmcnt(6)
    v_mfma_f32_32x32x16_bf16 v[96:111], v[40:43], v[224:227], v[96:111]
    v_subrev_u32 v8, 131072, v8
    ds_read_b64_tr_b16 v[40:41], v8 offset:0
    ds_read_b64_tr_b16 v[42:43], v8 offset:256
    s_waitcnt vmcnt(0)
    v_cmp_eq_u32 vcc, -1, v128
    s_and_b32 s62, vcc_lo, 307
    s_cselect_b32 s62, 1073741824, 0
    s_add_u32 s65, s66, s62
    s_add_u32 s54, s64, s62
    buffer_load_dwordx4 v[48:51], v10, s[4:7], s65 offen sc1
    s_waitcnt lgkmcnt(6)
    v_mfma_f32_32x32x16_bf16 v[96:111], v[44:47], v[228:231], v[96:111]
    ds_read_b64_tr_b16 v[44:45], v8 offset:3072
    ds_read_b64_tr_b16 v[46:47], v8 offset:3328
    s_add_u32 m0, s69, 32768
    s_lshl_b32 s3, s71, 13
    s_add_u32 s3, s3, s41
    s_and_b32 s3, s3, 0xffff
    s_add_u32 s65, s54, s3
    buffer_load_dwordx4 v10, s[4:7], s65 offen sc1 lds
    v_mul_f32 v156, v16, v16
    v_mul_f32 v157, v17, v17
    v_mul_f32 v158, v18, v18
    v_mul_f32 v159, v19, v19
    v_mul_f32 v160, v20, v20
    v_mul_f32 v161, v21, v21
    v_mul_f32 v162, v22, v22
    v_mul_f32 v163, v23, v23
    v_fmaak_f32 v156, v156, v6, 0xc0135761
    v_fmaak_f32 v157, v157, v6, 0xc0135761
    s_waitcnt lgkmcnt(6)
    v_mfma_f32_32x32x16_bf16 v[96:111], v[32:35], v[232:235], v[96:111]
    ds_read_b64_tr_b16 v[32:33], v8 offset:6144
    ds_read_b64_tr_b16 v[34:35], v8 offset:6400
    buffer_load_dwordx4 v10, s[4:7], s65 offen offset:1024 sc1 lds
    v_fmaak_f32 v158, v158, v6, 0xc0135761
    v_fmaak_f32 v159, v159, v6, 0xc0135761
    v_fmaak_f32 v160, v160, v6, 0xc0135761
    v_fmaak_f32 v161, v161, v6, 0xc0135761
    v_fmaak_f32 v162, v162, v6, 0xc0135761
    v_fmaak_f32 v163, v163, v6, 0xc0135761
    v_mul_f32 v156, v16, v156
    v_mul_f32 v157, v17, v157
    v_mul_f32 v158, v18, v158
    v_mul_f32 v159, v19, v159
    s_waitcnt lgkmcnt(6)
    v_mfma_f32_32x32x16_bf16 v[96:111], v[36:39], v[236:239], v[96:111]
    ds_read_b64_tr_b16 v[36:37], v8 offset:9216
    ds_read_b64_tr_b16 v[38:39], v8 offset:9472
    s_add_u32 m0, s69, 34816
    s_add_u32 s65, s65, 0x200000
    buffer_load_dwordx4 v10, s[4:7], s65 offen sc1 lds
    v_mul_f32 v160, v20, v160
    v_mul_f32 v161, v21, v161
    v_mul_f32 v162, v22, v162
    v_mul_f32 v163, v23, v163
    v_exp_f32 v156, v156
    v_exp_f32 v157, v157
    v_exp_f32 v158, v158
    v_exp_f32 v159, v159
    v_exp_f32 v160, v160
    v_exp_f32 v161, v161
    s_waitcnt lgkmcnt(6)
    v_mfma_f32_32x32x16_bf16 v[96:111], v[40:43], v[240:243], v[96:111]
    ds_read_b64_tr_b16 v[40:41], v9 offset:38912
    ds_read_b64_tr_b16 v[42:43], v9 offset:39168
    buffer_load_dwordx4 v10, s[4:7], s65 offen offset:1024 sc1 lds
    v_exp_f32 v162, v162
    v_exp_f32 v163, v163
    v_mul_f32 v16, v16, v24
    v_mul_f32 v17, v17, v25
    v_mul_f32 v18, v18, v26
    v_mul_f32 v19, v19, v27
    v_mul_f32 v20, v20, v28
    v_mul_f32 v21, v21, v29
    v_mul_f32 v22, v22, v30
    v_mul_f32 v23, v23, v31
    s_waitcnt lgkmcnt(6)
    v_mfma_f32_32x32x16_bf16 v[96:111], v[44:47], v[244:247], v[96:111]
    ds_read_b64_tr_b16 v[44:45], v9 offset:41984
    ds_read_b64_tr_b16 v[46:47], v9 offset:42240
    s_add_u32 m0, s69, 65536
    s_add_u32 s3, s3, 16384
    s_and_b32 s3, s3, 0xffff
    s_add_u32 s65, s54, s3
    buffer_load_dwordx4 v10, s[4:7], s65 offen sc1 lds
    v_add_f32 v156, 1.0, v156
    v_add_f32 v157, 1.0, v157
    v_add_f32 v158, 1.0, v158
    v_add_f32 v159, 1.0, v159
    v_add_f32 v160, 1.0, v160
    v_add_f32 v161, 1.0, v161
    v_add_f32 v162, 1.0, v162
    v_add_f32 v163, 1.0, v163
    v_rcp_f32 v156, v156
    v_rcp_f32 v157, v157
    s_waitcnt lgkmcnt(6)
    v_mfma_f32_32x32x16_bf16 v[96:111], v[32:35], v[248:251], v[96:111]
    v_add_u32 v9, 65536, v9
    ds_read_b64_tr_b16 v[32:33], v9 offset:0
    ds_read_b64_tr_b16 v[34:35], v9 offset:256
    buffer_load_dwordx4 v10, s[4:7], s65 offen offset:1024 sc1 lds
    v_rcp_f32 v158, v158
    v_rcp_f32 v159, v159
    v_rcp_f32 v160, v160
    v_rcp_f32 v161, v161
    v_rcp_f32 v162, v162
    v_rcp_f32 v163, v163
    v_mul_f32 v16, v16, v156
    v_mul_f32 v17, v17, v157
    v_mul_f32 v18, v18, v158
    v_mul_f32 v19, v19, v159
    s_waitcnt lgkmcnt(6)
    v_mfma_f32_32x32x16_bf16 v[96:111], v[36:39], v[252:255], v[96:111]
    ds_read_b64_tr_b16 v[36:37], v9 offset:3072
    ds_read_b64_tr_b16 v[38:39], v9 offset:3328
    s_add_u32 m0, s69, 67584
    s_add_u32 s65, s65, 0x200000
    buffer_load_dwordx4 v10, s[4:7], s65 offen sc1 lds
    v_mul_f32 v20, v20, v160
    v_mul_f32 v21, v21, v161
    v_mul_f32 v22, v22, v162
    v_mul_f32 v23, v23, v163
    v_cvt_pk_bf16_f32 v164, v16, v17
    v_cvt_pk_bf16_f32 v165, v18, v19
    v_cvt_pk_bf16_f32 v166, v20, v21
    v_cvt_pk_bf16_f32 v167, v22, v23
    s_add_u32 s63, s49, s63
    buffer_store_dwordx4 v[164:167], v10, s[4:7], s63 offen offset:0 sc1
    s_waitcnt lgkmcnt(6)
    v_mfma_f32_32x32x16_bf16 v[112:127], v[40:43], v[216:219], v[112:127]
    ds_read_b64_tr_b16 v[40:41], v9 offset:6144
    ds_read_b64_tr_b16 v[42:43], v9 offset:6400
    buffer_load_dwordx4 v10, s[4:7], s65 offen offset:1024 sc1 lds
    s_waitcnt lgkmcnt(6)
    v_mfma_f32_32x32x16_bf16 v[112:127], v[44:47], v[220:223], v[112:127]
    ds_read_b64_tr_b16 v[44:45], v9 offset:9216
    ds_read_b64_tr_b16 v[46:47], v9 offset:9472
    buffer_load_dword v128, v0, s[4:7], s67 offen sc1
    s_waitcnt lgkmcnt(6)
    v_mfma_f32_32x32x16_bf16 v[112:127], v[32:35], v[224:227], v[112:127]
    v_subrev_u32 v9, 131072, v9
    ds_read_b64_tr_b16 v[32:33], v9 offset:0
    ds_read_b64_tr_b16 v[34:35], v9 offset:256
    s_waitcnt lgkmcnt(6)
    v_mfma_f32_32x32x16_bf16 v[112:127], v[36:39], v[228:231], v[112:127]
    ds_read_b64_tr_b16 v[36:37], v9 offset:3072
    ds_read_b64_tr_b16 v[38:39], v9 offset:3328
    v_mul_f32 v168, v96, v96
    v_mul_f32 v169, v97, v97
    v_mul_f32 v170, v98, v98
    v_mul_f32 v171, v99, v99
    v_mul_f32 v172, v100, v100
    v_mul_f32 v173, v101, v101
    v_mul_f32 v174, v102, v102
    v_mul_f32 v175, v103, v103
    v_fmaak_f32 v168, v168, v6, 0xc0135761
    v_fmaak_f32 v169, v169, v6, 0xc0135761
    s_waitcnt lgkmcnt(6)
    v_mfma_f32_32x32x16_bf16 v[112:127], v[40:43], v[232:235], v[112:127]
    ds_read_b64_tr_b16 v[40:41], v9 offset:6144
    ds_read_b64_tr_b16 v[42:43], v9 offset:6400
    v_fmaak_f32 v170, v170, v6, 0xc0135761
    v_fmaak_f32 v171, v171, v6, 0xc0135761
    v_fmaak_f32 v172, v172, v6, 0xc0135761
    v_fmaak_f32 v173, v173, v6, 0xc0135761
    v_fmaak_f32 v174, v174, v6, 0xc0135761
    v_fmaak_f32 v175, v175, v6, 0xc0135761
    v_mul_f32 v168, v96, v168
    v_mul_f32 v169, v97, v169
    v_mul_f32 v170, v98, v170
    v_mul_f32 v171, v99, v171
    s_waitcnt lgkmcnt(6)
    v_mfma_f32_32x32x16_bf16 v[112:127], v[44:47], v[236:239], v[112:127]
    ds_read_b64_tr_b16 v[44:45], v9 offset:9216
    ds_read_b64_tr_b16 v[46:47], v9 offset:9472
    v_mul_f32 v172, v100, v172
    v_mul_f32 v173, v101, v173
    v_mul_f32 v174, v102, v174
    v_mul_f32 v175, v103, v175
    v_exp_f32 v168, v168
    v_exp_f32 v169, v169
    v_exp_f32 v170, v170
    v_exp_f32 v171, v171
    v_exp_f32 v172, v172
    v_exp_f32 v173, v173
    s_waitcnt lgkmcnt(6)
    v_mfma_f32_32x32x16_bf16 v[112:127], v[32:35], v[240:243], v[112:127]
    v_exp_f32 v174, v174
    v_exp_f32 v175, v175
    v_mul_f32 v96, v96, v104
    v_mul_f32 v97, v97, v105
    v_mul_f32 v98, v98, v106
    v_mul_f32 v99, v99, v107
    v_mul_f32 v100, v100, v108
    v_mul_f32 v101, v101, v109
    v_mul_f32 v102, v102, v110
    v_mul_f32 v103, v103, v111
    s_waitcnt lgkmcnt(4)
    v_mfma_f32_32x32x16_bf16 v[112:127], v[36:39], v[244:247], v[112:127]
    v_add_f32 v168, 1.0, v168
    v_add_f32 v169, 1.0, v169
    v_add_f32 v170, 1.0, v170
    v_add_f32 v171, 1.0, v171
    v_add_f32 v172, 1.0, v172
    v_add_f32 v173, 1.0, v173
    v_add_f32 v174, 1.0, v174
    v_add_f32 v175, 1.0, v175
    v_rcp_f32 v168, v168
    v_rcp_f32 v169, v169
    s_waitcnt lgkmcnt(2)
    v_mfma_f32_32x32x16_bf16 v[112:127], v[40:43], v[248:251], v[112:127]
    v_rcp_f32 v170, v170
    v_rcp_f32 v171, v171
    v_rcp_f32 v172, v172
    v_rcp_f32 v173, v173
    v_rcp_f32 v174, v174
    v_rcp_f32 v175, v175
    v_mul_f32 v96, v96, v168
    v_mul_f32 v97, v97, v169
    v_mul_f32 v98, v98, v170
    v_mul_f32 v99, v99, v171
    s_waitcnt lgkmcnt(0)
    v_mfma_f32_32x32x16_bf16 v[112:127], v[44:47], v[252:255], v[112:127]
    v_mul_f32 v100, v100, v172
    v_mul_f32 v101, v101, v173
    v_mul_f32 v102, v102, v174
    v_mul_f32 v103, v103, v175
    v_cvt_pk_bf16_f32 v176, v96, v97
    v_cvt_pk_bf16_f32 v177, v98, v99
    v_cvt_pk_bf16_f32 v178, v100, v101
    v_cvt_pk_bf16_f32 v179, v102, v103
    buffer_store_dwordx4 v[176:179], v10, s[4:7], s49 offen offset:0 sc1
    s_cmp_lg_u32 s62, 0
    s_cbranch_scc1 KF_NA
KF_B1A:
    s_waitcnt vmcnt(10)
    ds_read_b128 v[52:55], v131
    s_nop 7
    v_pk_mul_f32 v[144:145], v[112:113], v[112:113]
    v_pk_mul_f32 v[146:147], v[114:115], v[114:115]
    v_pk_mul_f32 v[148:149], v[116:117], v[116:117]
    v_pk_mul_f32 v[150:151], v[118:119], v[118:119]
    v_pk_fma_f32 v[144:145], v[144:145], v[132:133], v[132:133] op_sel:[0,0,1] op_sel_hi:[1,0,1]
    v_pk_fma_f32 v[146:147], v[146:147], v[132:133], v[132:133] op_sel:[0,0,1] op_sel_hi:[1,0,1]
    v_pk_fma_f32 v[148:149], v[148:149], v[132:133], v[132:133] op_sel:[0,0,1] op_sel_hi:[1,0,1]
    v_pk_fma_f32 v[150:151], v[150:151], v[132:133], v[132:133] op_sel:[0,0,1] op_sel_hi:[1,0,1]
    v_pk_mul_f32 v[144:145], v[112:113], v[144:145]
    v_pk_mul_f32 v[146:147], v[114:115], v[146:147]
    v_pk_mul_f32 v[148:149], v[116:117], v[148:149]
    v_pk_mul_f32 v[150:151], v[118:119], v[150:151]
    s_waitcnt lgkmcnt(0)
    v_mfma_f32_32x32x16_bf16 v[32:47], v[52:55], v[48:51], 0
    v_exp_f32 v144, v144
    v_exp_f32 v145, v145
    v_exp_f32 v146, v146
    v_exp_f32 v147, v147
    v_exp_f32 v148, v148
    v_exp_f32 v149, v149
    v_exp_f32 v150, v150
    v_exp_f32 v151, v151
    v_pk_mul_f32 v[112:113], v[112:113], v[120:121]
    v_pk_mul_f32 v[114:115], v[114:115], v[122:123]
    v_pk_mul_f32 v[116:117], v[116:117], v[124:125]
    v_pk_mul_f32 v[118:119], v[118:119], v[126:127]
    v_pk_add_f32 v[144:145], v[144:145], 1.0 op_sel_hi:[1,0]
    v_pk_add_f32 v[146:147], v[146:147], 1.0 op_sel_hi:[1,0]
    v_max3_f32 v3, v32, v33, v34
    v_max3_f32 v3, v3, v35, v36
    v_max3_f32 v3, v3, v37, v38
    v_max3_f32 v3, v3, v39, v40
    v_max3_f32 v3, v3, v41, v42
    v_max3_f32 v3, v3, v43, v44
    v_max3_f32 v3, v3, v45, v46
    v_max_f32 v3, v3, v47
    v_mov_b32 v130, v3
    v_pk_add_f32 v[148:149], v[148:149], 1.0 op_sel_hi:[1,0]
    v_pk_add_f32 v[150:151], v[150:151], 1.0 op_sel_hi:[1,0]
    v_permlane32_swap_b32 v3, v130
    v_rcp_f32 v144, v144
    v_rcp_f32 v145, v145
    v_max_f32 v3, v3, v130
    v_rcp_f32 v146, v146
    v_sub_f32 v80, 0, v3
    v_sub_f32 v81, 0, v3
    v_sub_f32 v82, 0, v3
    v_sub_f32 v83, 0, v3
    v_sub_f32 v84, 0, v3
    v_sub_f32 v85, 0, v3
    v_sub_f32 v86, 0, v3
    v_sub_f32 v87, 0, v3
    v_sub_f32 v88, 0, v3
    v_sub_f32 v89, 0, v3
    v_sub_f32 v90, 0, v3
    v_sub_f32 v91, 0, v3
    v_sub_f32 v92, 0, v3
    v_sub_f32 v93, 0, v3
    v_sub_f32 v94, 0, v3
    v_sub_f32 v95, 0, v3
    v_rcp_f32 v147, v147
    v_rcp_f32 v148, v148
    v_rcp_f32 v149, v149
    v_rcp_f32 v150, v150
    v_rcp_f32 v151, v151
    v_pk_mul_f32 v[112:113], v[112:113], v[144:145]
    v_pk_mul_f32 v[114:115], v[114:115], v[146:147]
    v_pk_mul_f32 v[116:117], v[116:117], v[148:149]
    v_pk_mul_f32 v[118:119], v[118:119], v[150:151]
    v_cvt_pk_bf16_f32 v152, v112, v113
    v_cvt_pk_bf16_f32 v153, v114, v115
    v_cvt_pk_bf16_f32 v154, v116, v117
    v_cvt_pk_bf16_f32 v155, v118, v119
    buffer_store_dwordx4 v[152:155], v10, s[4:7], s49 offen offset:1024 sc1
    s_waitcnt vmcnt(2)
    v_cmp_eq_u32 vcc, -1, v128
    s_or_b32 s74, s62, vcc_lo
    s_cbranch_scc1 KF_LATE
    s_branch KF_ATT
KF_P2C:
    s_waitcnt lgkmcnt(6)
    v_mfma_f32_32x32x16_bf16 v[96:111], v[32:35], v[128:131], 0
    ds_read_b64_tr_b16 v[32:33], v8 offset:38912
    ds_read_b64_tr_b16 v[34:35], v8 offset:39168
    s_waitcnt lgkmcnt(6)
    v_mfma_f32_32x32x16_bf16 v[112:127], v[36:39], v[128:131], 0
    ds_read_b64_tr_b16 v[36:37], v9 offset:38912
    ds_read_b64_tr_b16 v[38:39], v9 offset:39168
    v_mul_f32 v16, v64, v64
    v_mul_f32 v17, v65, v65
    v_mul_f32 v18, v66, v66
    v_mul_f32 v19, v67, v67
    v_mul_f32 v20, v68, v68
    s_waitcnt lgkmcnt(6)
    v_mfma_f32_32x32x16_bf16 v[96:111], v[40:43], v[132:135], v[96:111]
    ds_read_b64_tr_b16 v[40:41], v8 offset:41984
    ds_read_b64_tr_b16 v[42:43], v8 offset:42240
    v_mul_f32 v21, v69, v69
    v_mul_f32 v22, v70, v70
    v_mul_f32 v23, v71, v71
    v_fmaak_f32 v16, v16, v6, 0xc0135761
    s_waitcnt lgkmcnt(6)
    v_mfma_f32_32x32x16_bf16 v[112:127], v[44:47], v[132:135], v[112:127]
    ds_read_b64_tr_b16 v[44:45], v9 offset:41984
    ds_read_b64_tr_b16 v[46:47], v9 offset:42240
    v_fmaak_f32 v17, v17, v6, 0xc0135761
    v_fmaak_f32 v18, v18, v6, 0xc0135761
    v_fmaak_f32 v19, v19, v6, 0xc0135761
    v_fmaak_f32 v20, v20, v6, 0xc0135761
    s_waitcnt lgkmcnt(6)
    v_mfma_f32_32x32x16_bf16 v[96:111], v[32:35], v[136:139], v[96:111]
    s_waitcnt vmcnt(4)
    s_barrier
    v_add_u32 v8, 65536, v8
    ds_read_b64_tr_b16 v[32:33], v8 offset:0
    ds_read_b64_tr_b16 v[34:35], v8 offset:256
    v_fmaak_f32 v21, v21, v6, 0xc0135761
    v_fmaak_f32 v22, v22, v6, 0xc0135761
    v_fmaak_f32 v23, v23, v6, 0xc0135761
    v_mul_f32 v16, v64, v16
    s_waitcnt lgkmcnt(6)
    v_mfma_f32_32x32x16_bf16 v[112:127], v[36:39], v[136:139], v[112:127]
    v_add_u32 v9, 65536, v9
    ds_read_b64_tr_b16 v[36:37], v9 offset:0
    ds_read_b64_tr_b16 v[38:39], v9 offset:256
    v_mul_f32 v17, v65, v17
    v_mul_f32 v18, v66, v18
    v_mul_f32 v19, v67, v19
    v_mul_f32 v20, v68, v20
    s_waitcnt lgkmcnt(6)
    v_mfma_f32_32x32x16_bf16 v[96:111], v[40:43], v[140:143], v[96:111]
    ds_read_b64_tr_b16 v[40:41], v8 offset:3072
    ds_read_b64_tr_b16 v[42:43], v8 offset:3328
    v_mul_f32 v21, v69, v21
    v_mul_f32 v22, v70, v22
    v_mul_f32 v23, v71, v23
    v_exp_f32 v16, v16
    v_exp_f32 v17, v17
    s_waitcnt lgkmcnt(6)
    v_mfma_f32_32x32x16_bf16 v[112:127], v[44:47], v[140:143], v[112:127]
    ds_read_b64_tr_b16 v[44:45], v9 offset:3072
    ds_read_b64_tr_b16 v[46:47], v9 offset:3328
    v_exp_f32 v18, v18
    v_exp_f32 v19, v19
    v_exp_f32 v20, v20
    v_exp_f32 v21, v21
    s_waitcnt lgkmcnt(6)
    v_mfma_f32_32x32x16_bf16 v[96:111], v[32:35], v[144:147], v[96:111]
    s_add_u32 m0, s42, 32768
    s_add_u32 s3, s3, 128
    s_and_b32 s3, s3, 1023
    s_mul_i32 s45, s3, 1376
    ds_read_b64_tr_b16 v[32:33], v8 offset:6144
    ds_read_b64_tr_b16 v[34:35], v8 offset:6400
    buffer_load_dwordx4 v11, s[16:19], s45 offen offset:0 lds
    v_exp_f32 v22, v22
    v_exp_f32 v23, v23
    v_mul_f32 v64, v64, v72
    v_mul_f32 v65, v65, v73
    s_waitcnt lgkmcnt(6)
    v_mfma_f32_32x32x16_bf16 v[112:127], v[36:39], v[144:147], v[112:127]
    s_add_u32 m0, s42, 33728
    ds_read_b64_tr_b16 v[36:37], v9 offset:6144
    ds_read_b64_tr_b16 v[38:39], v9 offset:6400
    buffer_load_dwordx4 v11, s[16:19], s45 offen offset:64 lds
    v_mul_f32 v66, v66, v74
    v_mul_f32 v67, v67, v75
    v_mul_f32 v68, v68, v76
    v_mul_f32 v69, v69, v77
    s_waitcnt lgkmcnt(6)
    v_mfma_f32_32x32x16_bf16 v[96:111], v[40:43], v[148:151], v[96:111]
    s_add_u32 m0, s42, 34688
    ds_read_b64_tr_b16 v[40:41], v8 offset:9216
    ds_read_b64_tr_b16 v[42:43], v8 offset:9472
    buffer_load_dwordx4 v12, s[16:19], s45 offen offset:128 lds
    v_mul_f32 v70, v70, v78
    v_mul_f32 v71, v71, v79
    v_add_f32 v16, 1.0, v16
    v_add_f32 v17, 1.0, v17
    s_waitcnt lgkmcnt(6)
    v_mfma_f32_32x32x16_bf16 v[112:127], v[44:47], v[148:151], v[112:127]
    ds_read_b64_tr_b16 v[44:45], v9 offset:9216
    ds_read_b64_tr_b16 v[46:47], v9 offset:9472
    v_add_f32 v18, 1.0, v18
    v_add_f32 v19, 1.0, v19
    v_add_f32 v20, 1.0, v20
    v_add_f32 v21, 1.0, v21
    s_waitcnt lgkmcnt(6)
    v_mfma_f32_32x32x16_bf16 v[96:111], v[32:35], v[152:155], v[96:111]
    s_waitcnt vmcnt(3)
    s_barrier
    s_add_u32 m0, s42, 65536
    s_add_u32 s3, s3, 128
    s_and_b32 s3, s3, 1023
    s_mul_i32 s45, s3, 1376
    v_subrev_u32 v8, 131072, v8
    ds_read_b64_tr_b16 v[32:33], v8 offset:0
    ds_read_b64_tr_b16 v[34:35], v8 offset:256
    buffer_load_dwordx4 v11, s[16:19], s45 offen offset:0 lds
    v_add_f32 v22, 1.0, v22
    v_add_f32 v23, 1.0, v23
    v_rcp_f32 v16, v16
    v_rcp_f32 v17, v17
    v_rcp_f32 v18, v18
    s_waitcnt lgkmcnt(6)
    v_mfma_f32_32x32x16_bf16 v[112:127], v[36:39], v[152:155], v[112:127]
    v_subrev_u32 v9, 131072, v9
    ds_read_b64_tr_b16 v[36:37], v9 offset:0
    ds_read_b64_tr_b16 v[38:39], v9 offset:256
    v_rcp_f32 v19, v19
    v_rcp_f32 v20, v20
    v_rcp_f32 v21, v21
    v_rcp_f32 v22, v22
    s_waitcnt lgkmcnt(6)
    v_mfma_f32_32x32x16_bf16 v[96:111], v[40:43], v[156:159], v[96:111]
    s_add_u32 m0, s42, 66496
    ds_read_b64_tr_b16 v[40:41], v8 offset:3072
    ds_read_b64_tr_b16 v[42:43], v8 offset:3328
    buffer_load_dwordx4 v11, s[16:19], s45 offen offset:64 lds
    v_rcp_f32 v23, v23
    v_mul_f32 v64, v64, v16
    v_mul_f32 v65, v65, v17
    v_mul_f32 v66, v66, v18
    s_waitcnt lgkmcnt(6)
    v_mfma_f32_32x32x16_bf16 v[112:127], v[44:47], v[156:159], v[112:127]
    ds_read_b64_tr_b16 v[44:45], v9 offset:3072
    ds_read_b64_tr_b16 v[46:47], v9 offset:3328
    v_mul_f32 v67, v67, v19
    v_mul_f32 v68, v68, v20
    v_mul_f32 v69, v69, v21
    v_mul_f32 v70, v70, v22
    s_waitcnt lgkmcnt(6)
    v_mfma_f32_32x32x16_bf16 v[96:111], v[32:35], v[160:163], v[96:111]
    s_add_u32 m0, s42, 67456
    ds_read_b64_tr_b16 v[32:33], v8 offset:6144
    ds_read_b64_tr_b16 v[34:35], v8 offset:6400
    buffer_load_dwordx4 v12, s[16:19], s45 offen offset:128 lds
    v_mul_f32 v71, v71, v23
    v_cvt_pk_bf16_f32 v24, v64, v65
    v_cvt_pk_bf16_f32 v25, v66, v67
    v_cvt_pk_bf16_f32 v26, v68, v69
    s_waitcnt lgkmcnt(6)
    v_mfma_f32_32x32x16_bf16 v[112:127], v[36:39], v[160:163], v[112:127]
    ds_read_b64_tr_b16 v[36:37], v9 offset:6144
    ds_read_b64_tr_b16 v[38:39], v9 offset:6400
    v_cvt_pk_bf16_f32 v27, v70, v71
    s_sub_u32 s74, s49, 4096
    buffer_store_dwordx4 v[24:27], v10, s[4:7], s74 offen offset:0 sc1
    v_mul_f32 v16, v80, v80
    v_mul_f32 v17, v81, v81
    v_mul_f32 v18, v82, v82
    s_waitcnt lgkmcnt(6)
    v_mfma_f32_32x32x16_bf16 v[96:111], v[40:43], v[164:167], v[96:111]
    s_add_u32 m0, s42, 98304
    s_add_u32 s3, s3, 128
    s_and_b32 s3, s3, 1023
    s_mul_i32 s45, s3, 1376
    ds_read_b64_tr_b16 v[40:41], v8 offset:9216
    ds_read_b64_tr_b16 v[42:43], v8 offset:9472
    buffer_load_dwordx4 v11, s[16:19], s45 offen offset:0 lds
    v_mul_f32 v19, v83, v83
    v_mul_f32 v20, v84, v84
    v_mul_f32 v21, v85, v85
    v_mul_f32 v22, v86, v86
    s_waitcnt lgkmcnt(6)
    v_mfma_f32_32x32x16_bf16 v[112:127], v[44:47], v[164:167], v[112:127]
    ds_read_b64_tr_b16 v[44:45], v9 offset:9216
    ds_read_b64_tr_b16 v[46:47], v9 offset:9472
    v_mul_f32 v23, v87, v87
    v_fmaak_f32 v16, v16, v6, 0xc0135761
    v_fmaak_f32 v17, v17, v6, 0xc0135761
    v_fmaak_f32 v18, v18, v6, 0xc0135761
    s_waitcnt lgkmcnt(6)
    v_mfma_f32_32x32x16_bf16 v[96:111], v[32:35], v[168:171], v[96:111]
    s_waitcnt vmcnt(5)
    v_cmp_eq_u32 vcc, s40, v14
    s_cmp_lg_u64 vcc, 0
    s_cbranch_scc1 S0C_SP
S0C_OK:
    s_barrier
    s_mov_b64 exec, 1
    buffer_store_dword v2, off, s[4:7], s56 sc1
    s_mov_b64 exec, -1
    s_add_u32 m0, s42, 99264
    ds_read_b64_tr_b16 v[32:33], v8 offset:32768
    ds_read_b64_tr_b16 v[34:35], v8 offset:33024
    buffer_load_dwordx4 v11, s[16:19], s45 offen offset:64 lds
    v_fmaak_f32 v19, v19, v6, 0xc0135761
    v_fmaak_f32 v20, v20, v6, 0xc0135761
    v_fmaak_f32 v21, v21, v6, 0xc0135761
    v_fmaak_f32 v22, v22, v6, 0xc0135761
    s_waitcnt lgkmcnt(6)
    v_mfma_f32_32x32x16_bf16 v[112:127], v[36:39], v[168:171], v[112:127]
    ds_read_b64_tr_b16 v[36:37], v9 offset:32768
    ds_read_b64_tr_b16 v[38:39], v9 offset:33024
    v_fmaak_f32 v23, v23, v6, 0xc0135761
    v_mul_f32 v16, v80, v16
    v_mul_f32 v17, v81, v17
    v_mul_f32 v18, v82, v18
    s_waitcnt lgkmcnt(6)
    v_mfma_f32_32x32x16_bf16 v[96:111], v[40:43], v[172:175], v[96:111]
    s_add_u32 m0, s42, 100224
    ds_read_b64_tr_b16 v[40:41], v8 offset:35840
    ds_read_b64_tr_b16 v[42:43], v8 offset:36096
    buffer_load_dwordx4 v12, s[16:19], s45 offen offset:128 lds
    v_mul_f32 v19, v83, v19
    v_mul_f32 v20, v84, v20
    v_mul_f32 v21, v85, v21
    v_mul_f32 v22, v86, v22
    s_lshr_b32 s54, s40, 1
    s_lshl1_add_u32 s54, s71, s54
    s_waitcnt lgkmcnt(6)
    v_mfma_f32_32x32x16_bf16 v[112:127], v[44:47], v[172:175], v[112:127]
    ds_read_b64_tr_b16 v[44:45], v9 offset:35840
    ds_read_b64_tr_b16 v[46:47], v9 offset:36096
    v_mul_f32 v23, v87, v23
    v_exp_f32 v16, v16
    v_exp_f32 v17, v17
    v_exp_f32 v18, v18
    v_exp_f32 v19, v19
    v_and_b32 v0, 3, v2
    v_lshl_add_u32 v0, v0, 2, s54
    s_waitcnt lgkmcnt(6)
    v_mfma_f32_32x32x16_bf16 v[96:111], v[32:35], v[176:179], v[96:111]
    s_add_u32 m0, s42, 131072
    s_add_u32 s3, s3, 128
    s_and_b32 s3, s3, 1023
    s_mul_i32 s45, s3, 1376
    ds_read_b64_tr_b16 v[32:33], v8 offset:38912
    ds_read_b64_tr_b16 v[34:35], v8 offset:39168
    buffer_load_dwordx4 v11, s[16:19], s45 offen offset:0 lds
    v_exp_f32 v20, v20
    v_exp_f32 v21, v21
    v_exp_f32 v22, v22
    v_exp_f32 v23, v23
    v_and_b32 v0, 15, v0
    v_and_b32 v1, 4, v2
    s_waitcnt lgkmcnt(6)
    v_mfma_f32_32x32x16_bf16 v[112:127], v[36:39], v[176:179], v[112:127]
    ds_read_b64_tr_b16 v[36:37], v9 offset:38912
    ds_read_b64_tr_b16 v[38:39], v9 offset:39168
    v_mul_f32 v80, v80, v88
    v_mul_f32 v81, v81, v89
    v_mul_f32 v82, v82, v90
    v_mul_f32 v83, v83, v91
    v_lshlrev_b32 v0, 7, v0
    v_lshl_add_u32 v0, v1, 3, v0
    s_waitcnt lgkmcnt(6)
    v_mfma_f32_32x32x16_bf16 v[96:111], v[40:43], v[180:183], v[96:111]
    s_add_u32 m0, s42, 132032
    ds_read_b64_tr_b16 v[40:41], v8 offset:41984
    ds_read_b64_tr_b16 v[42:43], v8 offset:42240
    buffer_load_dwordx4 v11, s[16:19], s45 offen offset:64 lds
    v_mul_f32 v84, v84, v92
    v_mul_f32 v85, v85, v93
    v_mul_f32 v86, v86, v94
    v_mul_f32 v87, v87, v95
    v_add_u32 v0, 32, v0
    s_waitcnt lgkmcnt(6)
    v_mfma_f32_32x32x16_bf16 v[112:127], v[44:47], v[180:183], v[112:127]
    ds_read_b64_tr_b16 v[44:45], v9 offset:41984
    ds_read_b64_tr_b16 v[46:47], v9 offset:42240
    v_add_f32 v16, 1.0, v16
    v_add_f32 v17, 1.0, v17
    v_add_f32 v18, 1.0, v18
    v_add_f32 v19, 1.0, v19
    s_mov_b64 vcc, 0xff
    v_cndmask_b32 v0, 1073741824, v0, vcc
    s_waitcnt lgkmcnt(6)
    v_mfma_f32_32x32x16_bf16 v[96:111], v[32:35], v[184:187], v[96:111]
    s_waitcnt vmcnt(7)
    s_barrier
    s_add_u32 m0, s42, 132992
    v_add_u32 v8, 65536, v8
    ds_read_b64_tr_b16 v[32:33], v8 offset:0
    ds_read_b64_tr_b16 v[34:35], v8 offset:256
    buffer_load_dwordx4 v12, s[16:19], s45 offen offset:128 lds
    v_add_f32 v20, 1.0, v20
    v_add_f32 v21, 1.0, v21
    v_add_f32 v22, 1.0, v22
    v_add_f32 v23, 1.0, v23
    v_rcp_f32 v16, v16
    s_lshl1_add_u32 s54, s71, s68
    s_lshl_b32 s54, s54, 7
    s_waitcnt lgkmcnt(6)
    v_mfma_f32_32x32x16_bf16 v[112:127], v[36:39], v[184:187], v[112:127]
    v_add_u32 v9, 65536, v9
    ds_read_b64_tr_b16 v[36:37], v9 offset:0
    ds_read_b64_tr_b16 v[38:39], v9 offset:256
    v_rcp_f32 v17, v17
    v_rcp_f32 v18, v18
    v_rcp_f32 v19, v19
    v_rcp_f32 v20, v20
    v_writelane_b32 v0, s54, 8
    s_bfe_u32 s62, s70, 0x20001
    s_waitcnt lgkmcnt(6)
    v_mfma_f32_32x32x16_bf16 v[96:111], v[40:43], v[188:191], v[96:111]
    s_add_u32 m0, s42, 0
    s_add_u32 s3, s3, 128
    s_and_b32 s3, s3, 1023
    s_mul_i32 s45, s3, 1376
    ds_read_b64_tr_b16 v[40:41], v8 offset:3072
    ds_read_b64_tr_b16 v[42:43], v8 offset:3328
    buffer_load_dwordx4 v11, s[16:19], s45 offen offset:0 lds
    v_rcp_f32 v21, v21
    v_rcp_f32 v22, v22
    v_rcp_f32 v23, v23
    v_mul_f32 v80, v80, v16
    s_lshl_b32 s62, s62, 5
    s_add_u32 s54, s54, s62
    s_waitcnt lgkmcnt(6)
    v_mfma_f32_32x32x16_bf16 v[112:127], v[44:47], v[188:191], v[112:127]
    s_add_u32 m0, s42, 960
    ds_read_b64_tr_b16 v[44:45], v9 offset:3072
    ds_read_b64_tr_b16 v[46:47], v9 offset:3328
    buffer_load_dwordx4 v11, s[16:19], s45 offen offset:64 lds
    v_mul_f32 v81, v81, v17
    v_mul_f32 v82, v82, v18
    v_mul_f32 v83, v83, v19
    v_mul_f32 v84, v84, v20
    v_writelane_b32 v0, s54, 9
    s_waitcnt lgkmcnt(6)
    v_mfma_f32_32x32x16_bf16 v[96:111], v[32:35], v[192:195], v[96:111]
    s_add_u32 m0, s42, 1920
    ds_read_b64_tr_b16 v[32:33], v8 offset:6144
    ds_read_b64_tr_b16 v[34:35], v8 offset:6400
    buffer_load_dwordx4 v12, s[16:19], s45 offen offset:128 lds
    v_mul_f32 v85, v85, v21
    v_mul_f32 v86, v86, v22
    v_mul_f32 v87, v87, v23
    v_cvt_pk_bf16_f32 v24, v80, v81
    s_waitcnt lgkmcnt(6)
    v_mfma_f32_32x32x16_bf16 v[112:127], v[36:39], v[192:195], v[112:127]
    ds_read_b64_tr_b16 v[36:37], v9 offset:6144
    ds_read_b64_tr_b16 v[38:39], v9 offset:6400
    v_cvt_pk_bf16_f32 v25, v82, v83
    v_cvt_pk_bf16_f32 v26, v84, v85
    v_cvt_pk_bf16_f32 v27, v86, v87
    buffer_store_dwordx4 v[24:27], v10, s[4:7], s74 offen offset:1024 sc1
    s_waitcnt lgkmcnt(6)
    v_mfma_f32_32x32x16_bf16 v[96:111], v[40:43], v[196:199], v[96:111]
    ds_read_b64_tr_b16 v[40:41], v8 offset:9216
    ds_read_b64_tr_b16 v[42:43], v8 offset:9472
    v_lshrrev_b32 v3, 3, v2
    v_and_b32 v4, 7, v2
    v_lshlrev_b32 v4, 4, v4
    v_and_b32 v5, 16, v2
    v_lshlrev_b32 v14, 2, v5
    s_waitcnt lgkmcnt(6)
    v_mfma_f32_32x32x16_bf16 v[112:127], v[44:47], v[196:199], v[112:127]
    ds_read_b64_tr_b16 v[44:45], v9 offset:9216
    ds_read_b64_tr_b16 v[46:47], v9 offset:9472
    v_xor_b32 v4, v4, v14
    v_lshl_add_u32 v14, v3, 10, v4
    s_lshl_b32 s74, s71, 7
    v_add_u32 v14, s74, v14
    s_lshl_b32 s43, s40, 14
    s_waitcnt lgkmcnt(6)
    v_mfma_f32_32x32x16_bf16 v[96:111], v[32:35], v[200:203], v[96:111]
    s_waitcnt vmcnt(7)
    s_barrier
    ds_read_b64_tr_b16 v[32:33], v8 offset:32768
    ds_read_b64_tr_b16 v[34:35], v8 offset:33024
    v_lshrrev_b32 v3, 5, v2
    v_bfe_u32 v4, v2, 2, 2
    v_lshl_add_u32 v4, v3, 3, v4
    v_lshlrev_b32 v4, 7, v4
    v_lshl_add_u32 v4, v5, 1, v4
    s_waitcnt lgkmcnt(6)
    v_mfma_f32_32x32x16_bf16 v[112:127], v[36:39], v[200:203], v[112:127]
    ds_read_b64_tr_b16 v[36:37], v9 offset:32768
    ds_read_b64_tr_b16 v[38:39], v9 offset:33024
    v_and_b32 v5, 1, v2
    v_lshl_add_u32 v4, v5, 4, v4
    v_and_b32 v5, 2, v2
    v_lshl_add_u32 v4, v5, 2, v4
    v_and_b32 v5, 8, v2
    s_waitcnt lgkmcnt(6)
    v_mfma_f32_32x32x16_bf16 v[96:111], v[40:43], v[204:207], v[96:111]
    ds_read_b64_tr_b16 v[40:41], v8 offset:35840
    ds_read_b64_tr_b16 v[42:43], v8 offset:36096
    v_lshl_add_u32 v4, v5, 3, v4
    s_lshr_b32 s74, s40, 1
    s_lshl_b32 s42, s74, 17
    s_lshl_b32 s75, s74, 5
    s_add_u32 s75, s75, s69
    s_waitcnt lgkmcnt(6)
    v_mfma_f32_32x32x16_bf16 v[112:127], v[44:47], v[204:207], v[112:127]
    ds_read_b64_tr_b16 v[44:45], v9 offset:35840
    ds_read_b64_tr_b16 v[46:47], v9 offset:36096
    v_xor_b32 v4, s75, v4
    v_xor_b32 v5, 64, v4
    v_and_b32 v1, 15, v2
    v_lshlrev_b32 v1, 4, v1
    v_lshl_add_u32 v12, v3, 8, v1
    s_waitcnt lgkmcnt(6)
    v_mfma_f32_32x32x16_bf16 v[96:111], v[32:35], v[208:211], v[96:111]
    ds_read_b64_tr_b16 v[32:33], v8 offset:38912
    ds_read_b64_tr_b16 v[34:35], v8 offset:39168
    v_add_u32 v12, 0x8800, v12
    v_add_u32 v13, 0x10000, v12
    s_lshl_b32 s74, s74, 3
    s_and_b32 s75, s40, 1
    s_lshl1_add_u32 s75, s70, s75
    s_waitcnt lgkmcnt(6)
    v_mfma_f32_32x32x16_bf16 v[112:127], v[36:39], v[208:211], v[112:127]
    ds_read_b64_tr_b16 v[36:37], v8 offset:41984
    ds_read_b64_tr_b16 v[38:39], v8 offset:42240
    s_mul_i32 s44, s75, 86
    s_add_u32 s44, s44, s40
    s_lshl_b32 s44, s44, 10
    s_add_u32 s44, s44, 6291456
    s_xor_b32 s45, s75, 1
    s_waitcnt lgkmcnt(6)
    v_mfma_f32_32x32x16_bf16 v[96:111], v[40:43], v[212:215], v[96:111]
    s_waitcnt vmcnt(1)
    s_barrier
    v_add_u32 v8, 65536, v8
    ds_read_b64_tr_b16 v[40:41], v8 offset:0
    ds_read_b64_tr_b16 v[42:43], v8 offset:256
    s_mul_i32 s45, s45, 86
    s_add_u32 s45, s45, s40
    s_lshl_b32 s45, s45, 10
    s_add_u32 s45, s45, 6291456
    s_lshl_b32 s46, s72, 5
    s_waitcnt lgkmcnt(6)
    v_mfma_f32_32x32x16_bf16 v[112:127], v[44:47], v[212:215], v[112:127]
    ds_read_b64_tr_b16 v[44:45], v8 offset:3072
    ds_read_b64_tr_b16 v[46:47], v8 offset:3328
    s_add_u32 s46, s46, s70
    s_lshl_b32 s46, s46, 10
    s_add_u32 s46, s46, 12582912
    s_lshl_b32 s47, s75, 5
    s_waitcnt lgkmcnt(6)
    v_mfma_f32_32x32x16_bf16 v[96:111], v[32:35], v[216:219], v[96:111]
    ds_read_b64_tr_b16 v[32:33], v8 offset:6144
    ds_read_b64_tr_b16 v[34:35], v8 offset:6400
    s_add_u32 s47, s47, s74
    s_lshl_b32 s47, s47, 10
    s_add_u32 s47, s47, 12582912
    s_add_u32 s48, s47, 4096
    s_lshl_b32 s51, s72, 7
    s_waitcnt lgkmcnt(6)
    v_mfma_f32_32x32x16_bf16 v[96:111], v[36:39], v[220:223], v[96:111]
    ds_read_b64_tr_b16 v[36:37], v8 offset:9216
    ds_read_b64_tr_b16 v[38:39], v8 offset:9472
    s_add_u32 s51, s51, 16777216
    s_lshl_b32 s52, s75, 7
    s_add_u32 s52, s52, 16777216
    s_xor_b32 s53, s52, 128
    s_mul_i32 s55, s70, 176128
    s_waitcnt lgkmcnt(6)
    v_mfma_f32_32x32x16_bf16 v[96:111], v[40:43], v[224:227], v[96:111]
    v_subrev_u32 v8, 131072, v8
    ds_read_b64_tr_b16 v[40:41], v8 offset:0
    ds_read_b64_tr_b16 v[42:43], v8 offset:256
    s_add_u32 s55, s55, 6291456
    s_mul_i32 s59, s72, 2816
    s_mov_b32 s56, 0xffff
    s_mov_b32 s57, 0xffff
    v_add_u32 v7, 0x8000, v10
    s_waitcnt lgkmcnt(6)
    v_mfma_f32_32x32x16_bf16 v[96:111], v[44:47], v[228:231], v[96:111]
    ds_read_b64_tr_b16 v[44:45], v8 offset:3072
    ds_read_b64_tr_b16 v[46:47], v8 offset:3328
    v_add_u32 v11, 0x18000, v10
    v_add_u32 v131, s69, v7
    v_mov_b32 v132, v6
    v_mov_b32 v133, 0xc0135761
    v_mov_b32 v15, 0xdddd
    s_waitcnt lgkmcnt(6)
    v_mfma_f32_32x32x16_bf16 v[96:111], v[32:35], v[232:235], v[96:111]
    ds_read_b64_tr_b16 v[32:33], v8 offset:6144
    ds_read_b64_tr_b16 v[34:35], v8 offset:6400
    buffer_load_dword v128, v0, s[4:7], s67 offen sc1
    v_and_b32 v1, 31, v2
    v_lshlrev_b32 v1, 2, v1
    v_mov_b32 v56, 0
    s_mov_b32 exec_lo, 0x110000
    s_mov_b32 exec_hi, 0x110000
    v_mov_b32 v56, 0x3f803f80
    s_mov_b64 exec, -1
    v_mov_b32 v57, v56
    s_waitcnt lgkmcnt(6)
    v_mfma_f32_32x32x16_bf16 v[96:111], v[36:39], v[236:239], v[96:111]
    ds_read_b64_tr_b16 v[36:37], v8 offset:9216
    ds_read_b64_tr_b16 v[38:39], v8 offset:9472
    v_mov_b32 v58, v56
    v_mov_b32 v59, v56
    v_mov_b32 v60, v56
    v_mov_b32 v61, v56
    v_mov_b32 v62, v56
    s_waitcnt lgkmcnt(6)
    v_mfma_f32_32x32x16_bf16 v[96:111], v[40:43], v[240:243], v[96:111]
    ds_read_b64_tr_b16 v[40:41], v9 offset:38912
    ds_read_b64_tr_b16 v[42:43], v9 offset:39168
    v_mov_b32 v63, v56
    v_mov_b32 v64, 0
    v_mov_b32 v65, 0
    v_mov_b32 v66, 0
    v_mov_b32 v67, 0
    s_waitcnt lgkmcnt(6)
    v_mfma_f32_32x32x16_bf16 v[96:111], v[44:47], v[244:247], v[96:111]
    ds_read_b64_tr_b16 v[44:45], v9 offset:41984
    ds_read_b64_tr_b16 v[46:47], v9 offset:42240
    v_mov_b32 v68, 0
    v_mov_b32 v69, 0
    v_mov_b32 v70, 0
    v_mov_b32 v71, 0
    v_mov_b32 v72, 0
    s_waitcnt lgkmcnt(6)
    v_mfma_f32_32x32x16_bf16 v[96:111], v[32:35], v[248:251], v[96:111]
    v_add_u32 v9, 65536, v9
    ds_read_b64_tr_b16 v[32:33], v9 offset:0
    ds_read_b64_tr_b16 v[34:35], v9 offset:256
    s_waitcnt vmcnt(0)
    v_cmp_eq_u32 vcc, -1, v128
    s_and_b32 s62, vcc_lo, 307
    s_cselect_b32 s62, 1073741824, 0
    s_add_u32 s65, s66, s62
    s_add_u32 s54, s64, s62
    buffer_load_dwordx4 v[48:51], v10, s[4:7], s65 offen sc1
    s_add_u32 m0, s69, 32768
    s_lshl_b32 s3, s71, 13
    s_add_u32 s3, s3, s41
    s_and_b32 s3, s3, 0xffff
    s_add_u32 s65, s54, s3
    buffer_load_dwordx4 v10, s[4:7], s65 offen sc1 lds
    v_mov_b32 v73, 0
    v_mov_b32 v74, 0
    v_mov_b32 v75, 0
    v_mov_b32 v76, 0
    v_mov_b32 v77, 0
    s_waitcnt lgkmcnt(6)
    v_mfma_f32_32x32x16_bf16 v[96:111], v[36:39], v[252:255], v[96:111]
    ds_read_b64_tr_b16 v[36:37], v9 offset:3072
    ds_read_b64_tr_b16 v[38:39], v9 offset:3328
    buffer_load_dwordx4 v10, s[4:7], s65 offen offset:1024 sc1 lds
    v_mov_b32 v78, 0
    v_mov_b32 v79, 0
    s_lshl_b32 s75, s73, 17
    s_add_u32 s75, s75, s43
    s_waitcnt lgkmcnt(6)
    v_mfma_f32_32x32x16_bf16 v[112:127], v[40:43], v[216:219], v[112:127]
    ds_read_b64_tr_b16 v[40:41], v9 offset:6144
    ds_read_b64_tr_b16 v[42:43], v9 offset:6400
    s_add_u32 m0, s69, 34816
    s_add_u32 s65, s65, 0x200000
    buffer_load_dwordx4 v10, s[4:7], s65 offen sc1 lds
    buffer_load_dwordx4 v10, s[4:7], s65 offen offset:1024 sc1 lds
    s_waitcnt lgkmcnt(6)
    v_mfma_f32_32x32x16_bf16 v[112:127], v[44:47], v[220:223], v[112:127]
    ds_read_b64_tr_b16 v[44:45], v9 offset:9216
    ds_read_b64_tr_b16 v[46:47], v9 offset:9472
    s_add_u32 m0, s69, 65536
    s_add_u32 s3, s3, 16384
    s_and_b32 s3, s3, 0xffff
    s_add_u32 s65, s54, s3
    buffer_load_dwordx4 v10, s[4:7], s65 offen sc1 lds
    s_waitcnt lgkmcnt(6)
    v_mfma_f32_32x32x16_bf16 v[112:127], v[32:35], v[224:227], v[112:127]
    v_subrev_u32 v9, 131072, v9
    ds_read_b64_tr_b16 v[32:33], v9 offset:0
    ds_read_b64_tr_b16 v[34:35], v9 offset:256
    buffer_load_dwordx4 v10, s[4:7], s65 offen offset:1024 sc1 lds
    s_add_u32 m0, s69, 67584
    s_add_u32 s65, s65, 0x200000
    buffer_load_dwordx4 v10, s[4:7], s65 offen sc1 lds
    s_waitcnt lgkmcnt(6)
    v_mfma_f32_32x32x16_bf16 v[112:127], v[36:39], v[228:231], v[112:127]
    ds_read_b64_tr_b16 v[36:37], v9 offset:3072
    ds_read_b64_tr_b16 v[38:39], v9 offset:3328
    buffer_load_dwordx4 v10, s[4:7], s65 offen offset:1024 sc1 lds
    v_mul_f32 v156, v96, v96
    v_mul_f32 v157, v97, v97
    v_mul_f32 v158, v98, v98
    v_mul_f32 v159, v99, v99
    v_mul_f32 v160, v100, v100
    v_mul_f32 v161, v101, v101
    v_mul_f32 v162, v102, v102
    v_mul_f32 v163, v103, v103
    v_fmaak_f32 v156, v156, v6, 0xc0135761
    v_fmaak_f32 v157, v157, v6, 0xc0135761
    s_waitcnt lgkmcnt(6)
    v_mfma_f32_32x32x16_bf16 v[112:127], v[40:43], v[232:235], v[112:127]
    ds_read_b64_tr_b16 v[40:41], v9 offset:6144
    ds_read_b64_tr_b16 v[42:43], v9 offset:6400
    buffer_load_dword v128, v0, s[4:7], s67 offen sc1
    v_fmaak_f32 v158, v158, v6, 0xc0135761
    v_fmaak_f32 v159, v159, v6, 0xc0135761
    v_fmaak_f32 v160, v160, v6, 0xc0135761
    v_fmaak_f32 v161, v161, v6, 0xc0135761
    v_fmaak_f32 v162, v162, v6, 0xc0135761
    v_fmaak_f32 v163, v163, v6, 0xc0135761
    v_mul_f32 v156, v96, v156
    v_mul_f32 v157, v97, v157
    v_mul_f32 v158, v98, v158
    v_mul_f32 v159, v99, v159
    s_waitcnt lgkmcnt(6)
    v_mfma_f32_32x32x16_bf16 v[112:127], v[44:47], v[236:239], v[112:127]
    ds_read_b64_tr_b16 v[44:45], v9 offset:9216
    ds_read_b64_tr_b16 v[46:47], v9 offset:9472
    v_mul_f32 v160, v100, v160
    v_mul_f32 v161, v101, v161
    v_mul_f32 v162, v102, v162
    v_mul_f32 v163, v103, v163
    v_exp_f32 v156, v156
    v_exp_f32 v157, v157
    v_exp_f32 v158, v158
    v_exp_f32 v159, v159
    v_exp_f32 v160, v160
    v_exp_f32 v161, v161
    s_waitcnt lgkmcnt(6)
    v_mfma_f32_32x32x16_bf16 v[112:127], v[32:35], v[240:243], v[112:127]
    v_exp_f32 v162, v162
    v_exp_f32 v163, v163
    v_mul_f32 v96, v96, v104
    v_mul_f32 v97, v97, v105
    v_mul_f32 v98, v98, v106
    v_mul_f32 v99, v99, v107
    v_mul_f32 v100, v100, v108
    v_mul_f32 v101, v101, v109
    v_mul_f32 v102, v102, v110
    v_mul_f32 v103, v103, v111
    s_waitcnt lgkmcnt(4)
    v_mfma_f32_32x32x16_bf16 v[112:127], v[36:39], v[244:247], v[112:127]
    v_add_f32 v156, 1.0, v156
    v_add_f32 v157, 1.0, v157
    v_add_f32 v158, 1.0, v158
    v_add_f32 v159, 1.0, v159
    v_add_f32 v160, 1.0, v160
    v_add_f32 v161, 1.0, v161
    v_add_f32 v162, 1.0, v162
    v_add_f32 v163, 1.0, v163
    v_rcp_f32 v156, v156
    v_rcp_f32 v157, v157
    s_waitcnt lgkmcnt(2)
    v_mfma_f32_32x32x16_bf16 v[112:127], v[40:43], v[248:251], v[112:127]
    v_rcp_f32 v158, v158
    v_rcp_f32 v159, v159
    v_rcp_f32 v160, v160
    v_rcp_f32 v161, v161
    v_rcp_f32 v162, v162
    v_rcp_f32 v163, v163
    v_mul_f32 v96, v96, v156
    v_mul_f32 v97, v97, v157
    v_mul_f32 v98, v98, v158
    v_mul_f32 v99, v99, v159
    s_waitcnt lgkmcnt(0)
    v_mfma_f32_32x32x16_bf16 v[112:127], v[44:47], v[252:255], v[112:127]
    v_mul_f32 v100, v100, v160
    v_mul_f32 v101, v101, v161
    v_mul_f32 v102, v102, v162
    v_mul_f32 v103, v103, v163
    v_cvt_pk_bf16_f32 v164, v96, v97
    v_cvt_pk_bf16_f32 v165, v98, v99
    v_cvt_pk_bf16_f32 v166, v100, v101
    v_cvt_pk_bf16_f32 v167, v102, v103
    buffer_store_dwordx4 v[164:167], v10, s[4:7], s49 offen offset:0 sc1
    s_cmp_lg_u32 s62, 0
    s_cbranch_scc1 KF_NC
KF_B1C:
    s_waitcnt vmcnt(9)
    ds_read_b128 v[52:55], v131
    s_nop 7
    v_pk_mul_f32 v[144:145], v[112:113], v[112:113]
    v_pk_mul_f32 v[146:147], v[114:115], v[114:115]
    v_pk_mul_f32 v[148:149], v[116:117], v[116:117]
    v_pk_mul_f32 v[150:151], v[118:119], v[118:119]
    v_pk_fma_f32 v[144:145], v[144:145], v[132:133], v[132:133] op_sel:[0,0,1] op_sel_hi:[1,0,1]
    v_pk_fma_f32 v[146:147], v[146:147], v[132:133], v[132:133] op_sel:[0,0,1] op_sel_hi:[1,0,1]
    v_pk_fma_f32 v[148:149], v[148:149], v[132:133], v[132:133] op_sel:[0,0,1] op_sel_hi:[1,0,1]
    v_pk_fma_f32 v[150:151], v[150:151], v[132:133], v[132:133] op_sel:[0,0,1] op_sel_hi:[1,0,1]
    v_pk_mul_f32 v[144:145], v[112:113], v[144:145]
    v_pk_mul_f32 v[146:147], v[114:115], v[146:147]
    v_pk_mul_f32 v[148:149], v[116:117], v[148:149]
    v_pk_mul_f32 v[150:151], v[118:119], v[150:151]
    s_waitcnt lgkmcnt(0)
    v_mfma_f32_32x32x16_bf16 v[32:47], v[52:55], v[48:51], 0
    v_exp_f32 v144, v144
    v_exp_f32 v145, v145
    v_exp_f32 v146, v146
    v_exp_f32 v147, v147
    v_exp_f32 v148, v148
    v_exp_f32 v149, v149
    v_exp_f32 v150, v150
    v_exp_f32 v151, v151
    v_pk_mul_f32 v[112:113], v[112:113], v[120:121]
    v_pk_mul_f32 v[114:115], v[114:115], v[122:123]
    v_pk_mul_f32 v[116:117], v[116:117], v[124:125]
    v_pk_mul_f32 v[118:119], v[118:119], v[126:127]
    v_pk_add_f32 v[144:145], v[144:145], 1.0 op_sel_hi:[1,0]
    v_pk_add_f32 v[146:147], v[146:147], 1.0 op_sel_hi:[1,0]
    v_max3_f32 v3, v32, v33, v34
    v_max3_f32 v3, v3, v35, v36
    v_max3_f32 v3, v3, v37, v38
    v_max3_f32 v3, v3, v39, v40
    v_max3_f32 v3, v3, v41, v42
    v_max3_f32 v3, v3, v43, v44
    v_max3_f32 v3, v3, v45, v46
    v_max_f32 v3, v3, v47
    v_mov_b32 v130, v3
    v_pk_add_f32 v[148:149], v[148:149], 1.0 op_sel_hi:[1,0]
    v_pk_add_f32 v[150:151], v[150:151], 1.0 op_sel_hi:[1,0]
    v_permlane32_swap_b32 v3, v130
    v_rcp_f32 v144, v144
    v_rcp_f32 v145, v145
    v_max_f32 v3, v3, v130
    v_rcp_f32 v146, v146
    v_sub_f32 v80, 0, v3
    v_sub_f32 v81, 0, v3
    v_sub_f32 v82, 0, v3
    v_sub_f32 v83, 0, v3
    v_sub_f32 v84, 0, v3
    v_sub_f32 v85, 0, v3
    v_sub_f32 v86, 0, v3
    v_sub_f32 v87, 0, v3
    v_sub_f32 v88, 0, v3
    v_sub_f32 v89, 0, v3
    v_sub_f32 v90, 0, v3
    v_sub_f32 v91, 0, v3
    v_sub_f32 v92, 0, v3
    v_sub_f32 v93, 0, v3
    v_sub_f32 v94, 0, v3
    v_sub_f32 v95, 0, v3
    v_rcp_f32 v147, v147
    v_rcp_f32 v148, v148
    v_rcp_f32 v149, v149
    v_rcp_f32 v150, v150
    v_rcp_f32 v151, v151
    v_pk_mul_f32 v[112:113], v[112:113], v[144:145]
    v_pk_mul_f32 v[114:115], v[114:115], v[146:147]
    v_pk_mul_f32 v[116:117], v[116:117], v[148:149]
    v_pk_mul_f32 v[118:119], v[118:119], v[150:151]
    v_cvt_pk_bf16_f32 v152, v112, v113
    v_cvt_pk_bf16_f32 v153, v114, v115
    v_cvt_pk_bf16_f32 v154, v116, v117
    v_cvt_pk_bf16_f32 v155, v118, v119
    buffer_store_dwordx4 v[152:155], v10, s[4:7], s49 offen offset:1024 sc1
    s_waitcnt vmcnt(2)
    v_cmp_eq_u32 vcc, -1, v128
    s_or_b32 s74, s62, vcc_lo
    s_cbranch_scc1 KF_LATE
    s_branch KF_ATT
KF_LATE:
    s_cmp_eq_u32 s62, 1
    s_cbranch_scc1 KF_LW
KF_LP:
    s_sub_u32 s61, s61, 1
    s_cbranch_scc1 KF_LGIVE
    buffer_load_dword v128, v0, s[4:7], s67 offen sc1
    s_waitcnt vmcnt(0)
    v_cmp_eq_u32 vcc, -1, v128
    s_cmp_lg_u64 vcc, 0
    s_cbranch_scc1 KF_LP
KF_LGO:
    s_cmp_eq_u32 s62, 0
    s_cbranch_scc1 KF_ATT
    buffer_load_dwordx4 v[48:51], v10, s[4:7], s66 offen sc1
    s_add_u32 m0, s69, 32768
    s_lshl_b32 s3, s71, 13
    s_add_u32 s3, s3, s41
    s_and_b32 s3, s3, 0xffff
    s_add_u32 s65, s64, s3
    buffer_load_dwordx4 v10, s[4:7], s65 offen sc1 lds
    buffer_load_dwordx4 v10, s[4:7], s65 offen offset:1024 sc1 lds
    s_add_u32 m0, s69, 34816
    s_add_u32 s65, s65, 0x200000
    buffer_load_dwordx4 v10, s[4:7], s65 offen sc1 lds
    buffer_load_dwordx4 v10, s[4:7], s65 offen offset:1024 sc1 lds
    s_add_u32 m0, s69, 65536
    s_add_u32 s3, s3, 16384
    s_and_b32 s3, s3, 0xffff
    s_add_u32 s65, s64, s3
    buffer_load_dwordx4 v10, s[4:7], s65 offen sc1 lds
    buffer_load_dwordx4 v10, s[4:7], s65 offen offset:1024 sc1 lds
    s_add_u32 m0, s69, 67584
    s_add_u32 s65, s65, 0x200000
    buffer_load_dwordx4 v10, s[4:7], s65 offen sc1 lds
    buffer_load_dwordx4 v10, s[4:7], s65 offen offset:1024 sc1 lds
    s_waitcnt vmcnt(0)
KF_LW:
    s_waitcnt vmcnt(1)
    ds_read_b128 v[52:55], v131
    s_waitcnt lgkmcnt(0)
    v_mfma_f32_32x32x16_bf16 v[32:47], v[52:55], v[48:51], 0
    s_nop 11
    v_max3_f32 v3, v32, v33, v34
    v_max3_f32 v3, v3, v35, v36
    v_max3_f32 v3, v3, v37, v38
    v_max3_f32 v3, v3, v39, v40
    v_max3_f32 v3, v3, v41, v42
    v_max3_f32 v3, v3, v43, v44
    v_max3_f32 v3, v3, v45, v46
    v_max_f32 v3, v3, v47
    v_mov_b32 v6, v3
    s_nop 1
    v_permlane32_swap_b32 v3, v6
    s_nop 1
    v_max_f32 v3, v3, v6
    v_sub_f32 v80, 0, v3
    v_sub_f32 v81, 0, v3
    v_sub_f32 v82, 0, v3
    v_sub_f32 v83, 0, v3
    v_sub_f32 v84, 0, v3
    v_sub_f32 v85, 0, v3
    v_sub_f32 v86, 0, v3
    v_sub_f32 v87, 0, v3
    v_sub_f32 v88, 0, v3
    v_sub_f32 v89, 0, v3
    v_sub_f32 v90, 0, v3
    v_sub_f32 v91, 0, v3
    v_sub_f32 v92, 0, v3
    v_sub_f32 v93, 0, v3
    v_sub_f32 v94, 0, v3
    v_sub_f32 v95, 0, v3
    s_branch KF_ATT
KF_LGIVE:
    s_mov_b32 s61, 0
    s_branch KF_LGO
KF_CEND:
.section .rodata,"a"
.p2align 6
.amdhsa_kernel gated_mix__mha_block__geglu_ffn__prompt_kernel
  .amdhsa_next_free_vgpr 256
  .amdhsa_next_free_sgpr 102
  .amdhsa_accum_offset 256
  .amdhsa_group_segment_fixed_size 0
  .amdhsa_kernarg_size 88
  .amdhsa_user_sgpr_count 2
  .amdhsa_user_sgpr_kernarg_segment_ptr 1
  .amdhsa_system_sgpr_workgroup_id_x 1
.end_amdhsa_kernel
```
